```python
import torch

def _softmax(x, axis=-1):
    return torch.softmax(x, dim=axis)

def _gelu(x):
    return torch.nn.functional.gelu(x, approximate='tanh')

def _silu(x):
    return torch.nn.functional.silu(x)

def _sigmoid(x):
    return torch.sigmoid(x)

def _layernorm(x, axis=-1, eps=1e-05):
    m = x.mean(dim=axis, keepdim=True)
    v = x.var(dim=axis, keepdim=True, unbiased=False)
    return (x - m) / torch.sqrt(v + eps)

def _scatter_add(tgt, idx, src, axis=0):
    return tgt.clone().index_add_(axis, idx, src)

def _segment_sum(src, seg, n):
    out = torch.zeros((n,) + src.shape[1:], dtype=src.dtype)
    return out.index_add_(0, seg, src)

def _pad(x, pw):
    flat = tuple((v for pair in reversed(pw) for v in pair))
    return torch.nn.functional.pad(x, flat)
kernel_name = 'standalone__tree_speculative_verify_tree_attention_over_candidate_token_tree__sampling'

def setup_inputs():

    _w = lambda a: (lambda t: t.to(torch.bfloat16) if t.is_floating_point() else t)(torch.as_tensor(a))
    B, Hq, Hkv, T, C, D = (32, 32, 4, 16, 2048, 128)
    tree_mask = torch.zeros((B, T, T), dtype=float)
    for b in range(B):
        parent = torch.zeros(T, dtype=torch.int64)
        for i in range(1, T):
            parent[i] = int(torch.randint(0, i, (1,)).item())
        for i in range(T):
            j = i
            tree_mask[b, i, j] = 1.0
            while j > 0:
                j = parent[j]
                tree_mask[b, i, j] = 1.0
    return {'q': _w((lambda *s: torch.randn(*s, dtype=torch.bfloat16) * 0.8)(B, Hq, T, D)), 'k_cache': _w((lambda *s: torch.randn(*s, dtype=torch.bfloat16) * 0.8)(B, Hkv, C, D)), 'v_cache': _w((lambda *s: torch.randn(*s, dtype=torch.bfloat16) * 0.05)(B, Hkv, C, D)), 'k_tree': _w((lambda *s: torch.randn(*s, dtype=torch.bfloat16) * 0.8)(B, Hkv, T, D)), 'v_tree': _w((lambda *s: torch.randn(*s, dtype=torch.bfloat16) * 0.05)(B, Hkv, T, D)), 'tree_mask': _w(tree_mask)}

def reference(q, k_cache, v_cache, k_tree, v_tree, tree_mask):
    B, Hq, T, D = q.shape
    Hkv, C = (k_cache.shape[1], k_cache.shape[2])
    rep = Hq // Hkv
    kc = (lambda x, n, axis: torch.repeat_interleave(x, n, dim=axis))(k_cache, rep, axis=1)
    vc = (lambda x, n, axis: torch.repeat_interleave(x, n, dim=axis))(v_cache, rep, axis=1)
    kt = (lambda x, n, axis: torch.repeat_interleave(x, n, dim=axis))(k_tree, rep, axis=1)
    vt = (lambda x, n, axis: torch.repeat_interleave(x, n, dim=axis))(v_tree, rep, axis=1)
    k = torch.concatenate([kc, kt], axis=2)
    v = torch.concatenate([vc, vt], axis=2)
    scale = D ** (-0.5)
    scores = torch.einsum('bhqd,bhkd->bhqk', q, k) * scale
    ctx_mask = torch.ones((B, 1, T, C), dtype=scores.dtype)
    tm = tree_mask[:, None, :, :].clone()
    full_mask = torch.concatenate([ctx_mask, tm], axis=-1)
    scores = scores + (1.0 - full_mask) * -1000000000.0
    p = _softmax(scores, axis=-1)
    return torch.einsum('bhqk,bhkd->bhqd', p, v)
```

```asm
; @launch grid=(256,1,1) block=(320,1,1) lds=163840
.amdgcn_target "amdgcn-amd-amdhsa--gfx950"
.text
.globl standalone__tree_speculative_verify_tree_attention_over_candidate_token_tree__sampling_kernel
.p2align 8
.type standalone__tree_speculative_verify_tree_attention_over_candidate_token_tree__sampling_kernel,@function
standalone__tree_speculative_verify_tree_attention_over_candidate_token_tree__sampling_kernel:
    s_cmp_ge_u32 s2, 256
    s_cbranch_scc1 L_end
    s_load_dwordx16 s[4:19], s[0:1], 0
    s_load_dwordx2 s[20:21], s[0:1], 64
    v_lshrrev_b32 v1, 6, v0
    s_and_b32 s67, s2, 7
    v_readfirstlane_b32 s60, v1
    s_lshl_b32 s67, s67, 4
    s_lshr_b32 s70, s2, 4
    s_add_u32 s67, s67, s70
    s_bfe_u32 s68, s2, 0x10003
    s_cmp_ge_u32 s60, 1
    s_cbranch_scc1 L_compute
L_loader:
    v_lshrrev_b32 v17, 4, v0
    v_and_b32 v18, 15, v0
    v_xor_b32 v19, v18, v17
    v_lshlrev_b32 v20, 8, v17
    v_lshl_add_u32 v8, v19, 4, v20
    v_xor_b32 v9, 64, v8
    v_xor_b32 v10, 128, v8
    v_xor_b32 v11, 192, v8
    s_lshl_b32 s72, s67, 15
    s_mov_b32 s71, 0
    s_mov_b32 s34, 0x400000
    s_mov_b32 s35, 0x20000
    s_setprio 1
    s_waitcnt lgkmcnt(0)
    s_mov_b32 s32, s4
    s_and_b32 s33, s5, 0xffff
    s_add_u32 m0, s71, 131072
    s_nop 0
    buffer_load_dwordx4 v8, s[32:35], s72 offen offset:0 nt lds
    buffer_load_dwordx4 v9, s[32:35], s72 offen offset:1024 nt lds
    buffer_load_dwordx4 v10, s[32:35], s72 offen offset:2048 nt lds
    buffer_load_dwordx4 v11, s[32:35], s72 offen offset:3072 nt lds
    s_add_u32 m0, s71, 135168
    s_add_u32 s72, s72, 4096
    buffer_load_dwordx4 v8, s[32:35], s72 offen offset:0 nt lds
    buffer_load_dwordx4 v9, s[32:35], s72 offen offset:1024 nt lds
    buffer_load_dwordx4 v10, s[32:35], s72 offen offset:2048 nt lds
    buffer_load_dwordx4 v11, s[32:35], s72 offen offset:3072 nt lds
    s_add_u32 m0, s71, 139264
    s_add_u32 s72, s72, 4096
    buffer_load_dwordx4 v8, s[32:35], s72 offen offset:0 nt lds
    buffer_load_dwordx4 v9, s[32:35], s72 offen offset:1024 nt lds
    buffer_load_dwordx4 v10, s[32:35], s72 offen offset:2048 nt lds
    buffer_load_dwordx4 v11, s[32:35], s72 offen offset:3072 nt lds
    s_add_u32 m0, s71, 143360
    s_add_u32 s72, s72, 4096
    buffer_load_dwordx4 v8, s[32:35], s72 offen offset:0 nt lds
    buffer_load_dwordx4 v9, s[32:35], s72 offen offset:1024 nt lds
    buffer_load_dwordx4 v10, s[32:35], s72 offen offset:2048 nt lds
    buffer_load_dwordx4 v11, s[32:35], s72 offen offset:3072 nt lds
    s_add_u32 m0, s71, 147456
    s_add_u32 s72, s72, 4096
    buffer_load_dwordx4 v8, s[32:35], s72 offen offset:0 nt lds
    buffer_load_dwordx4 v9, s[32:35], s72 offen offset:1024 nt lds
    buffer_load_dwordx4 v10, s[32:35], s72 offen offset:2048 nt lds
    buffer_load_dwordx4 v11, s[32:35], s72 offen offset:3072 nt lds
    s_add_u32 m0, s71, 151552
    s_add_u32 s72, s72, 4096
    buffer_load_dwordx4 v8, s[32:35], s72 offen offset:0 nt lds
    buffer_load_dwordx4 v9, s[32:35], s72 offen offset:1024 nt lds
    buffer_load_dwordx4 v10, s[32:35], s72 offen offset:2048 nt lds
    buffer_load_dwordx4 v11, s[32:35], s72 offen offset:3072 nt lds
    s_add_u32 m0, s71, 155648
    s_add_u32 s72, s72, 4096
    buffer_load_dwordx4 v8, s[32:35], s72 offen offset:0 nt lds
    buffer_load_dwordx4 v9, s[32:35], s72 offen offset:1024 nt lds
    buffer_load_dwordx4 v10, s[32:35], s72 offen offset:2048 nt lds
    buffer_load_dwordx4 v11, s[32:35], s72 offen offset:3072 nt lds
    s_add_u32 m0, s71, 159744
    s_add_u32 s72, s72, 4096
    buffer_load_dwordx4 v8, s[32:35], s72 offen offset:0 nt lds
    buffer_load_dwordx4 v9, s[32:35], s72 offen offset:1024 nt lds
    buffer_load_dwordx4 v10, s[32:35], s72 offen offset:2048 nt lds
    buffer_load_dwordx4 v11, s[32:35], s72 offen offset:3072 nt lds
    s_mov_b32 s63, 0
    s_lshl_b32 s70, s67, 19
    s_lshl_b32 s61, s68, 18
    s_add_u32 s61, s61, s70
    s_mov_b32 s62, s61
    s_mov_b32 s24, s6
    s_and_b32 s25, s7, 0xffff
    s_mov_b32 s26, 67108864
    s_mov_b32 s27, 0x20000
    s_add_u32 m0, s63, 0
    s_waitcnt vmcnt(31)
    buffer_load_dwordx4 v8, s[24:27], s61 offen offset:0 nt lds
    s_waitcnt vmcnt(31)
    buffer_load_dwordx4 v9, s[24:27], s61 offen offset:1024 nt lds
    s_waitcnt vmcnt(31)
    buffer_load_dwordx4 v10, s[24:27], s61 offen offset:2048 nt lds
    s_waitcnt vmcnt(31)
    buffer_load_dwordx4 v11, s[24:27], s61 offen offset:3072 nt lds
    s_add_u32 s61, s61, 4096
    s_add_u32 m0, s63, 4096
    s_waitcnt vmcnt(31)
    buffer_load_dwordx4 v8, s[24:27], s61 offen offset:0 nt lds
    s_waitcnt vmcnt(31)
    buffer_load_dwordx4 v9, s[24:27], s61 offen offset:1024 nt lds
    s_waitcnt vmcnt(31)
    buffer_load_dwordx4 v10, s[24:27], s61 offen offset:2048 nt lds
    s_waitcnt vmcnt(31)
    buffer_load_dwordx4 v11, s[24:27], s61 offen offset:3072 nt lds
    s_add_u32 s61, s61, 4096
    v_lshlrev_b32 v22, 1, v17
    v_xor_b32 v22, v22, v18
    v_lshl_add_u32 v12, v22, 4, v20
    v_xor_b32 v13, 0x80, v12
    s_mov_b32 s28, s8
    s_and_b32 s29, s9, 0xffff
    s_mov_b32 s30, 67108864
    s_mov_b32 s31, 0x20000
    s_add_u32 m0, s63, 8192
    s_waitcnt vmcnt(31)
    buffer_load_dwordx4 v8, s[24:27], s61 offen offset:0 nt lds
    s_waitcnt vmcnt(31)
    buffer_load_dwordx4 v9, s[24:27], s61 offen offset:1024 nt lds
    s_waitcnt vmcnt(31)
    buffer_load_dwordx4 v10, s[24:27], s61 offen offset:2048 nt lds
    s_waitcnt vmcnt(31)
    buffer_load_dwordx4 v11, s[24:27], s61 offen offset:3072 nt lds
    s_add_u32 s61, s61, 4096
    s_add_u32 m0, s63, 12288
    s_waitcnt vmcnt(31)
    buffer_load_dwordx4 v8, s[24:27], s61 offen offset:0 nt lds
    s_waitcnt vmcnt(31)
    buffer_load_dwordx4 v9, s[24:27], s61 offen offset:1024 nt lds
    s_waitcnt vmcnt(31)
    buffer_load_dwordx4 v10, s[24:27], s61 offen offset:2048 nt lds
    s_waitcnt vmcnt(31)
    buffer_load_dwordx4 v11, s[24:27], s61 offen offset:3072 nt lds
    s_add_u32 s61, s61, 4096
    s_add_u32 m0, s63, 16384
    s_waitcnt vmcnt(31)
    buffer_load_dwordx4 v8, s[24:27], s61 offen offset:0 nt lds
    s_waitcnt vmcnt(31)
    buffer_load_dwordx4 v9, s[24:27], s61 offen offset:1024 nt lds
    s_waitcnt vmcnt(31)
    buffer_load_dwordx4 v10, s[24:27], s61 offen offset:2048 nt lds
    s_waitcnt vmcnt(31)
    buffer_load_dwordx4 v11, s[24:27], s61 offen offset:3072 nt lds
    s_add_u32 s61, s61, 4096
    s_add_u32 m0, s63, 20480
    s_waitcnt vmcnt(31)
    buffer_load_dwordx4 v8, s[24:27], s61 offen offset:0 nt lds
    s_waitcnt vmcnt(31)
    buffer_load_dwordx4 v9, s[24:27], s61 offen offset:1024 nt lds
    s_waitcnt vmcnt(31)
    buffer_load_dwordx4 v10, s[24:27], s61 offen offset:2048 nt lds
    s_waitcnt vmcnt(31)
    buffer_load_dwordx4 v11, s[24:27], s61 offen offset:3072 nt lds
    s_add_u32 s61, s61, 4096
    s_add_u32 m0, s63, 24576
    s_waitcnt vmcnt(31)
    buffer_load_dwordx4 v8, s[24:27], s61 offen offset:0 nt lds
    s_waitcnt vmcnt(31)
    buffer_load_dwordx4 v9, s[24:27], s61 offen offset:1024 nt lds
    s_waitcnt vmcnt(31)
    buffer_load_dwordx4 v10, s[24:27], s61 offen offset:2048 nt lds
    s_waitcnt vmcnt(31)
    buffer_load_dwordx4 v11, s[24:27], s61 offen offset:3072 nt lds
    s_add_u32 s61, s61, 4096
    s_add_u32 m0, s63, 28672
    s_waitcnt vmcnt(31)
    buffer_load_dwordx4 v8, s[24:27], s61 offen offset:0 nt lds
    s_waitcnt vmcnt(31)
    buffer_load_dwordx4 v9, s[24:27], s61 offen offset:1024 nt lds
    s_waitcnt vmcnt(31)
    buffer_load_dwordx4 v10, s[24:27], s61 offen offset:2048 nt lds
    s_waitcnt vmcnt(31)
    buffer_load_dwordx4 v11, s[24:27], s61 offen offset:3072 nt lds
    s_add_u32 s61, s61, 4096
    s_barrier
    s_add_u32 m0, s63, 65536
    s_waitcnt vmcnt(31)
    buffer_load_dwordx4 v12, s[28:31], s62 offen offset:0 nt lds
    s_waitcnt vmcnt(31)
    buffer_load_dwordx4 v13, s[28:31], s62 offen offset:1024 nt lds
    s_waitcnt vmcnt(31)
    buffer_load_dwordx4 v12, s[28:31], s62 offen offset:2048 nt lds
    s_waitcnt vmcnt(31)
    buffer_load_dwordx4 v13, s[28:31], s62 offen offset:3072 nt lds
    s_add_u32 s62, s62, 4096
    s_add_u32 m0, s63, 69632
    s_waitcnt vmcnt(31)
    buffer_load_dwordx4 v12, s[28:31], s62 offen offset:0 nt lds
    s_waitcnt vmcnt(31)
    buffer_load_dwordx4 v13, s[28:31], s62 offen offset:1024 nt lds
    s_waitcnt vmcnt(31)
    buffer_load_dwordx4 v12, s[28:31], s62 offen offset:2048 nt lds
    s_waitcnt vmcnt(31)
    buffer_load_dwordx4 v13, s[28:31], s62 offen offset:3072 nt lds
    s_add_u32 s62, s62, 4096
    s_add_u32 m0, s63, 73728
    s_waitcnt vmcnt(31)
    buffer_load_dwordx4 v12, s[28:31], s62 offen offset:0 nt lds
    s_waitcnt vmcnt(31)
    buffer_load_dwordx4 v13, s[28:31], s62 offen offset:1024 nt lds
    s_waitcnt vmcnt(31)
    buffer_load_dwordx4 v12, s[28:31], s62 offen offset:2048 nt lds
    s_waitcnt vmcnt(31)
    buffer_load_dwordx4 v13, s[28:31], s62 offen offset:3072 nt lds
    s_add_u32 s62, s62, 4096
    s_add_u32 m0, s63, 77824
    s_waitcnt vmcnt(31)
    buffer_load_dwordx4 v12, s[28:31], s62 offen offset:0 nt lds
    s_waitcnt vmcnt(31)
    buffer_load_dwordx4 v13, s[28:31], s62 offen offset:1024 nt lds
    s_waitcnt vmcnt(31)
    buffer_load_dwordx4 v12, s[28:31], s62 offen offset:2048 nt lds
    s_waitcnt vmcnt(31)
    buffer_load_dwordx4 v13, s[28:31], s62 offen offset:3072 nt lds
    s_add_u32 s62, s62, 4096
    s_barrier
    v_mov_b32 v16, v0
    v_lshrrev_b32 v25, 3, v0
    v_lshlrev_b32 v25, 8, v25
    v_and_b32 v21, 7, v22
    v_lshl_add_u32 v25, v21, 4, v25
    s_bfe_u32 s64, s2, 0x30003
    s_mov_b32 s74, 0
    s_mov_b32 s48, s16
    s_and_b32 s49, s17, 0xffff
    s_mov_b32 s50, 0x400000
    s_mov_b32 s51, 0x20000
    s_mov_b32 s52, s20
    s_and_b32 s53, s21, 0xffff
    s_mov_b32 s54, 0x10000000
    s_mov_b32 s55, 0x20000
    s_xor_b32 s76, s68, 1
    s_lshl_b32 s77, s67, 1
    s_add_u32 s77, s77, s76
    s_mul_i32 s77, s77, 2048
    s_lshl_b32 s76, s76, 7
    s_lshl_b32 s78, s67, 15
    s_add_u32 s76, s76, s78
    v_bfe_u32 v41, v0, 2, 2
    v_lshlrev_b32 v41, 9, v41
    v_and_b32 v42, 3, v0
    v_lshl_add_u32 v41, v42, 6, v41
    v_lshlrev_b32 v40, 8, v0
    s_mov_b32 s44, 2004318356
    s_mov_b32 s45, 16213878
    s_cmp_eq_u32 s64, 1
    s_cselect_b32 s44, 1735882901, s44
    s_cselect_b32 s45, 16213623, s45
    s_cmp_eq_u32 s64, 2
    s_cselect_b32 s44, 1987541142, s44
    s_cselect_b32 s45, 16152167, s45
    s_cmp_eq_u32 s64, 3
    s_cselect_b32 s44, 1987541143, s44
    s_cselect_b32 s45, 16148086, s45
    s_cmp_eq_u32 s64, 4
    s_cselect_b32 s44, 1987541144, s44
    s_cselect_b32 s45, 16148070, s45
    s_cmp_eq_u32 s64, 5
    s_cselect_b32 s44, 1719105689, s44
    s_cselect_b32 s45, 16148071, s45
    s_cmp_eq_u32 s64, 6
    s_cselect_b32 s44, 1734834330, s44
    s_cselect_b32 s45, 16148070, s45
    s_cmp_eq_u32 s64, 7
    s_cselect_b32 s44, 1734834331, s44
    s_cselect_b32 s45, 16143974, s45
    s_mov_b32 s36, 0
    s_mov_b32 s56, s18
    s_and_b32 s57, s19, 0xffff
    s_mov_b32 s58, 0x100
    s_mov_b32 s59, 0x20000
    s_and_b32 s70, s2, 7
    s_lshl_b32 s70, s70, 5
    v_and_b32 v50, 31, v0
    v_add_u32 v50, s70, v50
    s_lshr_b32 s73, s2, 3
    s_add_u32 s70, s70, s73
    v_mov_b32 v49, s70
    v_mov_b32 v48, 0
    s_and_b32 s46, s44, 15
    s_mov_b32 s47, 16384
    s_mov_b32 s66, 13
    s_mov_b64 vcc, -1
L_lloop:
L_lb0:
    v_add_u32 v48, 1, v48
    buffer_store_byte v48, v49, s[56:59], 0 offen
    buffer_load_ubyte v51, v50, s[56:59], 0 offen nt
    s_add_u32 s70, s47, 16384
    s_and_b32 s70, s70, 0xffff
    s_add_u32 m0, s70, 0
    s_waitcnt vmcnt(25)
    s_cbranch_vccz L_lw0_0
    s_waitcnt vmcnt(21)
L_lw0_0:
    buffer_load_dwordx4 v8, s[24:27], s61 offen offset:0 nt lds
    s_waitcnt vmcnt(25)
    s_cbranch_vccz L_lw0_1
    s_waitcnt vmcnt(21)
L_lw0_1:
    buffer_load_dwordx4 v9, s[24:27], s61 offen offset:1024 nt lds
    s_waitcnt vmcnt(25)
    s_cbranch_vccz L_lw0_2
    s_waitcnt vmcnt(21)
L_lw0_2:
    buffer_load_dwordx4 v10, s[24:27], s61 offen offset:2048 nt lds
    s_waitcnt vmcnt(25)
    s_cbranch_vccz L_lw0_3
    s_waitcnt vmcnt(21)
L_lw0_3:
    buffer_load_dwordx4 v11, s[24:27], s61 offen offset:3072 nt lds
    s_add_u32 s61, s61, 4096
    s_sub_u32 s46, s46, 1
    s_cbranch_scc0 L_lnb0_0
    s_barrier
    s_lshr_b64 s[44:45], s[44:45], 4
    s_and_b32 s46, s44, 15
L_lnb0_0:
    s_add_u32 m0, s70, 4096
    s_waitcnt vmcnt(25)
    s_cbranch_vccz L_lw1_0
    s_waitcnt vmcnt(21)
L_lw1_0:
    buffer_load_dwordx4 v8, s[24:27], s61 offen offset:0 nt lds
    s_waitcnt vmcnt(25)
    s_cbranch_vccz L_lw1_1
    s_waitcnt vmcnt(21)
L_lw1_1:
    buffer_load_dwordx4 v9, s[24:27], s61 offen offset:1024 nt lds
    s_waitcnt vmcnt(25)
    s_cbranch_vccz L_lw1_2
    s_waitcnt vmcnt(21)
L_lw1_2:
    buffer_load_dwordx4 v10, s[24:27], s61 offen offset:2048 nt lds
    s_waitcnt vmcnt(25)
    s_cbranch_vccz L_lw1_3
    s_waitcnt vmcnt(21)
L_lw1_3:
    buffer_load_dwordx4 v11, s[24:27], s61 offen offset:3072 nt lds
    s_add_u32 s61, s61, 4096
    s_sub_u32 s46, s46, 1
    s_cbranch_scc0 L_lnb0_1
    s_barrier
    s_lshr_b64 s[44:45], s[44:45], 4
    s_and_b32 s46, s44, 15
L_lnb0_1:
    s_add_u32 m0, s70, 8192
    s_waitcnt vmcnt(25)
    s_cbranch_vccz L_lw2_0
    s_waitcnt vmcnt(21)
L_lw2_0:
    buffer_load_dwordx4 v8, s[24:27], s61 offen offset:0 nt lds
    s_waitcnt vmcnt(25)
    s_cbranch_vccz L_lw2_1
    s_waitcnt vmcnt(21)
L_lw2_1:
    buffer_load_dwordx4 v9, s[24:27], s61 offen offset:1024 nt lds
    s_waitcnt vmcnt(25)
    s_cbranch_vccz L_lw2_2
    s_waitcnt vmcnt(21)
L_lw2_2:
    buffer_load_dwordx4 v10, s[24:27], s61 offen offset:2048 nt lds
    s_waitcnt vmcnt(25)
    s_cbranch_vccz L_lw2_3
    s_waitcnt vmcnt(21)
L_lw2_3:
    buffer_load_dwordx4 v11, s[24:27], s61 offen offset:3072 nt lds
    s_add_u32 s61, s61, 4096
    s_sub_u32 s46, s46, 1
    s_cbranch_scc0 L_lnb0_2
    s_barrier
    s_lshr_b64 s[44:45], s[44:45], 4
    s_and_b32 s46, s44, 15
L_lnb0_2:
    s_add_u32 m0, s70, 12288
    s_waitcnt vmcnt(25)
    s_cbranch_vccz L_lw3_0
    s_waitcnt vmcnt(21)
L_lw3_0:
    buffer_load_dwordx4 v8, s[24:27], s61 offen offset:0 nt lds
    s_waitcnt vmcnt(25)
    s_cbranch_vccz L_lw3_1
    s_waitcnt vmcnt(21)
L_lw3_1:
    buffer_load_dwordx4 v9, s[24:27], s61 offen offset:1024 nt lds
    s_waitcnt vmcnt(25)
    s_cbranch_vccz L_lw3_2
    s_waitcnt vmcnt(21)
L_lw3_2:
    buffer_load_dwordx4 v10, s[24:27], s61 offen offset:2048 nt lds
    s_waitcnt vmcnt(25)
    s_cbranch_vccz L_lw3_3
    s_waitcnt vmcnt(21)
L_lw3_3:
    buffer_load_dwordx4 v11, s[24:27], s61 offen offset:3072 nt lds
    s_add_u32 s61, s61, 4096
    s_sub_u32 s46, s46, 1
    s_cbranch_scc0 L_lnb0_3
    s_barrier
    s_lshr_b64 s[44:45], s[44:45], 4
    s_and_b32 s46, s44, 15
L_lnb0_3:
    s_add_u32 m0, s47, 65536
    s_waitcnt vmcnt(25)
    s_cbranch_vccz L_lw4_0
    s_waitcnt vmcnt(21)
L_lw4_0:
    buffer_load_dwordx4 v12, s[28:31], s62 offen offset:0 nt lds
    s_waitcnt vmcnt(25)
    s_cbranch_vccz L_lw4_1
    s_waitcnt vmcnt(21)
L_lw4_1:
    buffer_load_dwordx4 v13, s[28:31], s62 offen offset:1024 nt lds
    s_waitcnt vmcnt(25)
    s_cbranch_vccz L_lw4_2
    s_waitcnt vmcnt(21)
L_lw4_2:
    buffer_load_dwordx4 v12, s[28:31], s62 offen offset:2048 nt lds
    s_waitcnt vmcnt(25)
    s_cbranch_vccz L_lw4_3
    s_waitcnt vmcnt(21)
L_lw4_3:
    buffer_load_dwordx4 v13, s[28:31], s62 offen offset:3072 nt lds
    s_add_u32 s62, s62, 4096
    s_sub_u32 s46, s46, 1
    s_cbranch_scc0 L_lnb0_4
    s_barrier
    s_lshr_b64 s[44:45], s[44:45], 4
    s_and_b32 s46, s44, 15
L_lnb0_4:
    s_add_u32 m0, s47, 69632
    s_waitcnt vmcnt(25)
    s_cbranch_vccz L_lw5_0
    s_waitcnt vmcnt(19)
L_lw5_0:
    buffer_load_dwordx4 v12, s[28:31], s62 offen offset:0 nt lds
    s_waitcnt vmcnt(25)
    s_cbranch_vccz L_lw5_1
    s_waitcnt vmcnt(19)
L_lw5_1:
    buffer_load_dwordx4 v13, s[28:31], s62 offen offset:1024 nt lds
    s_waitcnt vmcnt(25)
    s_cbranch_vccz L_lw5_2
    s_waitcnt vmcnt(19)
L_lw5_2:
    buffer_load_dwordx4 v12, s[28:31], s62 offen offset:2048 nt lds
    s_waitcnt vmcnt(25)
    s_cbranch_vccz L_lw5_3
    s_waitcnt vmcnt(19)
L_lw5_3:
    buffer_load_dwordx4 v13, s[28:31], s62 offen offset:3072 nt lds
    s_add_u32 s62, s62, 4096
    s_sub_u32 s46, s46, 1
    s_cbranch_scc0 L_lnb0_5
    s_barrier
    s_lshr_b64 s[44:45], s[44:45], 4
    s_and_b32 s46, s44, 15
L_lnb0_5:
    s_add_u32 m0, s47, 73728
    s_waitcnt vmcnt(23)
    s_cbranch_vccz L_lw6_0
    s_waitcnt vmcnt(19)
L_lw6_0:
    buffer_load_dwordx4 v12, s[28:31], s62 offen offset:0 nt lds
    s_waitcnt vmcnt(23)
    s_cbranch_vccz L_lw6_1
    s_waitcnt vmcnt(19)
L_lw6_1:
    buffer_load_dwordx4 v13, s[28:31], s62 offen offset:1024 nt lds
    s_waitcnt vmcnt(23)
    s_cbranch_vccz L_lw6_2
    s_waitcnt vmcnt(19)
L_lw6_2:
    buffer_load_dwordx4 v12, s[28:31], s62 offen offset:2048 nt lds
    s_waitcnt vmcnt(23)
    s_cbranch_vccz L_lw6_3
    s_waitcnt vmcnt(19)
L_lw6_3:
    buffer_load_dwordx4 v13, s[28:31], s62 offen offset:3072 nt lds
    s_add_u32 s62, s62, 4096
    s_sub_u32 s46, s46, 1
    s_cbranch_scc0 L_lnb0_6
    s_barrier
    s_lshr_b64 s[44:45], s[44:45], 4
    s_and_b32 s46, s44, 15
L_lnb0_6:
    s_add_u32 m0, s47, 77824
    s_waitcnt vmcnt(23)
    s_cbranch_vccz L_lw7_0
    s_waitcnt vmcnt(19)
L_lw7_0:
    buffer_load_dwordx4 v12, s[28:31], s62 offen offset:0 nt lds
    s_waitcnt vmcnt(23)
    s_cbranch_vccz L_lw7_1
    s_waitcnt vmcnt(19)
L_lw7_1:
    buffer_load_dwordx4 v13, s[28:31], s62 offen offset:1024 nt lds
    s_waitcnt vmcnt(23)
    s_cbranch_vccz L_lw7_2
    s_waitcnt vmcnt(19)
L_lw7_2:
    buffer_load_dwordx4 v12, s[28:31], s62 offen offset:2048 nt lds
    s_waitcnt vmcnt(23)
    s_cbranch_vccz L_lw7_3
    s_waitcnt vmcnt(19)
L_lw7_3:
    buffer_load_dwordx4 v13, s[28:31], s62 offen offset:3072 nt lds
    s_add_u32 s62, s62, 4096
    v_cmp_ge_u32 s[38:39], v51, v48
    s_nop 0
    s_bcnt1_i32_b32 s36, s38
    s_cmp_gt_u32 s66, 10
    s_cselect_b32 s36, 0, s36
    s_cmp_lt_u32 s36, 28
    s_cselect_b64 vcc, -1, 0
    s_sub_u32 s46, s46, 1
    s_cbranch_scc0 L_lnb0_7
    s_barrier
    s_lshr_b64 s[44:45], s[44:45], 4
    s_and_b32 s46, s44, 15
L_lnb0_7:
    s_mov_b32 s47, s70
    s_sub_u32 s66, s66, 1
    s_cmp_lg_u32 s66, 0
    s_cbranch_scc1 L_lloop
L_ltail:
    s_add_u32 m0, s63, 49152
    s_waitcnt vmcnt(19)
    buffer_load_dwordx4 v8, s[24:27], s61 offen offset:0 nt lds
    s_waitcnt vmcnt(19)
    buffer_load_dwordx4 v9, s[24:27], s61 offen offset:1024 nt lds
    s_waitcnt vmcnt(19)
    buffer_load_dwordx4 v10, s[24:27], s61 offen offset:2048 nt lds
    s_waitcnt vmcnt(19)
    buffer_load_dwordx4 v11, s[24:27], s61 offen offset:3072 nt lds
    s_add_u32 s61, s61, 4096
    s_add_u32 m0, s63, 53248
    s_waitcnt vmcnt(19)
    buffer_load_dwordx4 v8, s[24:27], s61 offen offset:0 nt lds
    s_waitcnt vmcnt(19)
    buffer_load_dwordx4 v9, s[24:27], s61 offen offset:1024 nt lds
    s_waitcnt vmcnt(19)
    buffer_load_dwordx4 v10, s[24:27], s61 offen offset:2048 nt lds
    s_waitcnt vmcnt(19)
    buffer_load_dwordx4 v11, s[24:27], s61 offen offset:3072 nt lds
    s_add_u32 s61, s61, 4096
    s_add_u32 m0, s63, 57344
    s_waitcnt vmcnt(19)
    buffer_load_dwordx4 v8, s[24:27], s61 offen offset:0 nt lds
    s_waitcnt vmcnt(19)
    buffer_load_dwordx4 v9, s[24:27], s61 offen offset:1024 nt lds
    s_waitcnt vmcnt(19)
    buffer_load_dwordx4 v10, s[24:27], s61 offen offset:2048 nt lds
    s_waitcnt vmcnt(19)
    buffer_load_dwordx4 v11, s[24:27], s61 offen offset:3072 nt lds
    s_add_u32 s61, s61, 4096
    s_add_u32 m0, s63, 61440
    s_waitcnt vmcnt(19)
    buffer_load_dwordx4 v8, s[24:27], s61 offen offset:0 nt lds
    s_waitcnt vmcnt(19)
    buffer_load_dwordx4 v9, s[24:27], s61 offen offset:1024 nt lds
    s_waitcnt vmcnt(19)
    buffer_load_dwordx4 v10, s[24:27], s61 offen offset:2048 nt lds
    s_waitcnt vmcnt(19)
    buffer_load_dwordx4 v11, s[24:27], s61 offen offset:3072 nt lds
    s_add_u32 s61, s61, 4096
    s_lshl_b32 s71, s68, 7
    s_xor_b32 s71, s71, 128
    s_add_u32 s71, s71, s62
    s_mov_b32 m0, 98304
    s_waitcnt vmcnt(19)
    buffer_load_dwordx4 v25, s[28:31], s71 offen offset:0 nt lds
    s_add_u32 s71, s71, 2048
    s_mov_b32 m0, 99328
    s_waitcnt vmcnt(19)
    buffer_load_dwordx4 v25, s[28:31], s71 offen offset:0 nt lds
    s_add_u32 s71, s71, 2048
    s_mov_b32 m0, 100352
    s_waitcnt vmcnt(19)
    buffer_load_dwordx4 v25, s[28:31], s71 offen offset:0 nt lds
    s_add_u32 s71, s71, 2048
    s_mov_b32 m0, 101376
    s_waitcnt vmcnt(19)
    buffer_load_dwordx4 v25, s[28:31], s71 offen offset:0 nt lds
    s_barrier
    s_add_u32 s71, s71, 2048
    s_mov_b32 m0, 102400
    s_waitcnt vmcnt(19)
    buffer_load_dwordx4 v25, s[28:31], s71 offen offset:0 nt lds
    s_add_u32 s71, s71, 2048
    s_mov_b32 m0, 103424
    s_waitcnt vmcnt(19)
    buffer_load_dwordx4 v25, s[28:31], s71 offen offset:0 nt lds
    s_add_u32 s71, s71, 2048
    s_mov_b32 m0, 104448
    s_waitcnt vmcnt(19)
    buffer_load_dwordx4 v25, s[28:31], s71 offen offset:0 nt lds
    s_add_u32 s71, s71, 2048
    s_mov_b32 m0, 105472
    s_waitcnt vmcnt(19)
    buffer_load_dwordx4 v25, s[28:31], s71 offen offset:0 nt lds
    s_lshl_b32 s71, s68, 7
    s_xor_b32 s71, s71, 16512
    s_add_u32 s71, s71, s62
    s_mov_b32 m0, 114688
    s_waitcnt vmcnt(19)
    buffer_load_dwordx4 v25, s[28:31], s71 offen offset:0 nt lds
    s_add_u32 s71, s71, 2048
    s_mov_b32 m0, 115712
    s_waitcnt vmcnt(19)
    buffer_load_dwordx4 v25, s[28:31], s71 offen offset:0 nt lds
    s_add_u32 s71, s71, 2048
    s_mov_b32 m0, 116736
    s_waitcnt vmcnt(19)
    buffer_load_dwordx4 v25, s[28:31], s71 offen offset:0 nt lds
    s_add_u32 s71, s71, 2048
    s_mov_b32 m0, 117760
    s_waitcnt vmcnt(19)
    buffer_load_dwordx4 v25, s[28:31], s71 offen offset:0 nt lds
    s_add_u32 s71, s71, 2048
    s_mov_b32 m0, 118784
    s_waitcnt vmcnt(19)
    buffer_load_dwordx4 v25, s[28:31], s71 offen offset:0 nt lds
    s_add_u32 s71, s71, 2048
    s_mov_b32 m0, 119808
    s_waitcnt vmcnt(19)
    buffer_load_dwordx4 v25, s[28:31], s71 offen offset:0 nt lds
    s_add_u32 s71, s71, 2048
    s_mov_b32 m0, 120832
    s_waitcnt vmcnt(19)
    buffer_load_dwordx4 v25, s[28:31], s71 offen offset:0 nt lds
    s_add_u32 s71, s71, 2048
    s_mov_b32 m0, 121856
    s_waitcnt vmcnt(19)
    buffer_load_dwordx4 v25, s[28:31], s71 offen offset:0 nt lds
    s_lshl_b32 s71, s68, 7
    s_xor_b32 s71, s71, 0
    s_add_u32 s71, s71, s62
    s_mov_b32 m0, 106496
    s_waitcnt vmcnt(19)
    buffer_load_dwordx4 v25, s[28:31], s71 offen offset:0 nt lds
    s_add_u32 s71, s71, 2048
    s_mov_b32 m0, 107520
    s_waitcnt vmcnt(19)
    buffer_load_dwordx4 v25, s[28:31], s71 offen offset:0 nt lds
    s_add_u32 s71, s71, 2048
    s_mov_b32 m0, 108544
    s_waitcnt vmcnt(19)
    buffer_load_dwordx4 v25, s[28:31], s71 offen offset:0 nt lds
    s_add_u32 s71, s71, 2048
    s_mov_b32 m0, 109568
    s_waitcnt vmcnt(19)
    buffer_load_dwordx4 v25, s[28:31], s71 offen offset:0 nt lds
    s_barrier
    s_add_u32 s71, s71, 2048
    s_mov_b32 m0, 110592
    s_waitcnt vmcnt(19)
    buffer_load_dwordx4 v25, s[28:31], s71 offen offset:0 nt lds
    s_add_u32 s71, s71, 2048
    s_mov_b32 m0, 111616
    s_waitcnt vmcnt(19)
    buffer_load_dwordx4 v25, s[28:31], s71 offen offset:0 nt lds
    s_add_u32 s71, s71, 2048
    s_mov_b32 m0, 112640
    s_waitcnt vmcnt(19)
    buffer_load_dwordx4 v25, s[28:31], s71 offen offset:0 nt lds
    s_add_u32 s71, s71, 2048
    s_mov_b32 m0, 113664
    s_waitcnt vmcnt(19)
    buffer_load_dwordx4 v25, s[28:31], s71 offen offset:0 nt lds
    s_lshl_b32 s71, s68, 7
    s_xor_b32 s71, s71, 16384
    s_add_u32 s71, s71, s62
    s_mov_b32 m0, 122880
    s_waitcnt vmcnt(19)
    buffer_load_dwordx4 v25, s[28:31], s71 offen offset:0 nt lds
    s_add_u32 s71, s71, 2048
    s_mov_b32 m0, 123904
    s_waitcnt vmcnt(19)
    buffer_load_dwordx4 v25, s[28:31], s71 offen offset:0 nt lds
    s_add_u32 s71, s71, 2048
    s_mov_b32 m0, 124928
    s_waitcnt vmcnt(19)
    buffer_load_dwordx4 v25, s[28:31], s71 offen offset:0 nt lds
    s_add_u32 s71, s71, 2048
    s_mov_b32 m0, 125952
    s_waitcnt vmcnt(19)
    buffer_load_dwordx4 v25, s[28:31], s71 offen offset:0 nt lds
    s_barrier
    s_add_u32 s71, s71, 2048
    s_mov_b32 m0, 126976
    s_waitcnt vmcnt(19)
    buffer_load_dwordx4 v25, s[28:31], s71 offen offset:0 nt lds
    s_add_u32 s71, s71, 2048
    s_mov_b32 m0, 128000
    s_waitcnt vmcnt(19)
    buffer_load_dwordx4 v25, s[28:31], s71 offen offset:0 nt lds
    s_add_u32 s71, s71, 2048
    s_mov_b32 m0, 129024
    s_waitcnt vmcnt(19)
    buffer_load_dwordx4 v25, s[28:31], s71 offen offset:0 nt lds
    s_add_u32 s71, s71, 2048
    s_mov_b32 m0, 130048
    s_waitcnt vmcnt(19)
    buffer_load_dwordx4 v25, s[28:31], s71 offen offset:0 nt lds
    buffer_load_dword v42, v41, s[52:55], s77 offen
    buffer_load_dword v43, v40, s[48:51], s76 offen
    s_add_u32 s76, s76, 16384
    buffer_load_dword v44, v40, s[48:51], s76 offen
    s_add_u32 s76, s76, 16384
    s_waitcnt vmcnt(19)
    s_barrier
    s_waitcnt vmcnt(11)
    s_barrier
    s_waitcnt vmcnt(3)
    s_barrier
    s_endpgm
L_compute:
    s_sub_u32 s60, s60, 1
    v_and_b32 v250, 63, v0
    v_mov_b32 v251, 0
    s_mov_b32 s46, 16384
    s_mov_b32 s47, 0x20000
    s_mov_b32 s50, 4194304
    s_mov_b32 s51, 0x20000
    s_mov_b32 s54, 268435456
    s_mov_b32 s55, 0x20000
    v_lshrrev_b32 v241, 4, v250
    v_and_b32 v242, 15, v250
    v_lshlrev_b32 v243, 3, v241
    v_lshl_add_u32 v243, v242, 5, v243
    s_lshr_b32 s76, s67, 2
    s_lshl_b32 s76, s76, 9
    s_lshl_b32 s69, s67, 1
    s_add_u32 s69, s69, s68
    s_lshl_b32 s70, s69, 2
    s_add_u32 s70, s70, s60
    s_waitcnt lgkmcnt(0)
    s_mov_b32 s44, s14
    s_and_b32 s45, s15, 0xffff
    s_mov_b32 s48, s16
    s_and_b32 s49, s17, 0xffff
    s_mov_b32 s52, s20
    s_and_b32 s53, s21, 0xffff
    s_xor_b32 s81, s70, 4
    s_mul_i32 s69, s70, 512
    s_mul_i32 s81, s81, 512
    s_add_u32 s4, s69, 256
    s_add_u32 s5, s81, 256
    v_lshlrev_b32 v249, 2, v250
    s_cmp_eq_u32 s68, 0
    s_cbranch_scc1 L_notl
    s_mov_b32 s36, s10
    s_and_b32 s37, s11, 0xffff
    s_mov_b32 s38, 0x80000
    s_mov_b32 s39, 0x20000
    s_mov_b32 s40, s12
    s_and_b32 s41, s13, 0xffff
    s_mov_b32 s42, 0x80000
    s_mov_b32 s43, 0x20000
    v_lshlrev_b32 v244, 8, v241
    s_lshl_b32 s71, s60, 2
    v_xor_b32 v245, v241, v242
    v_xor_b32 v245, s71, v245
    v_lshl_add_u32 v245, v245, 4, v244
    s_and_b32 s71, s60, 1
    s_lshl_b32 s71, s71, 3
    v_lshlrev_b32 v246, 1, v241
    v_xor_b32 v246, v246, v242
    v_xor_b32 v246, s71, v246
    v_lshl_add_u32 v246, v246, 4, v244
    s_lshl_b32 s71, s60, 10
    s_lshl_b32 s72, s67, 12
    s_add_u32 s72, s72, s71
    s_add_u32 m0, s71, 114688
    s_nop 0
    buffer_load_dwordx4 v245, s[36:39], s72 offen nt lds
    s_add_u32 m0, s71, 118784
    s_nop 0
    buffer_load_dwordx4 v246, s[40:43], s72 offen nt lds
    buffer_load_dwordx2 v[252:253], v243, s[44:47], s76 offen
L_notl:
    s_mov_b32 s56, s18
    s_and_b32 s57, s19, 0xffff
    s_mov_b32 s58, 0x100
    s_mov_b32 s59, 0x20000
    buffer_load_dword v248, v249, s[56:59], 0 offen
    v_and_b32 v249, 0x7f, v249
    buffer_load_dword v254, v251, s[52:55], s4 offen sc1
    buffer_load_dword v255, v251, s[52:55], s5 offen sc1
    s_lshl_b32 s8, s67, 15
    s_lshl_b32 s71, s60, 13
    s_add_u32 s8, s8, s71
    s_lshl_b32 s72, s68, 7
    s_add_u32 s8, s8, s72
    v_xor_b32 v244, v241, v242
    v_lshlrev_b32 v245, 8, v242
    v_xor_b32 v246, 0, v244
    v_lshl_add_u32 v228, v246, 4, v245
    v_xor_b32 v246, 4, v244
    v_lshl_add_u32 v229, v246, 4, v245
    v_xor_b32 v246, 8, v244
    v_lshl_add_u32 v230, v246, 4, v245
    v_xor_b32 v246, 12, v244
    v_lshl_add_u32 v231, v246, 4, v245
    v_lshrrev_b32 v244, 2, v250
    v_lshlrev_b32 v245, 8, v244
    v_and_b32 v246, 1, v250
    v_lshl_add_u32 v245, v246, 3, v245
    v_add_u32 v245, 65536, v245
    v_bfe_u32 v246, v250, 1, 4
    s_lshl_b32 s77, s68, 3
    v_xor_b32 v246, s77, v246
    v_xor_b32 v247, 0, v246
    v_lshl_add_u32 v232, v247, 4, v245
    v_xor_b32 v247, 2, v246
    v_lshl_add_u32 v233, v247, 4, v245
    v_xor_b32 v247, 4, v246
    v_lshl_add_u32 v234, v247, 4, v245
    v_xor_b32 v247, 6, v246
    v_lshl_add_u32 v235, v247, 4, v245
    v_xor_b32 v247, 8, v246
    v_lshl_add_u32 v236, v247, 4, v245
    v_xor_b32 v247, 10, v246
    v_lshl_add_u32 v237, v247, 4, v245
    v_xor_b32 v247, 12, v246
    v_lshl_add_u32 v238, v247, 4, v245
    v_xor_b32 v247, 14, v246
    v_lshl_add_u32 v239, v247, 4, v245
    s_mov_b32 s65, 0x41000000
    v_mov_b64 v[0:1], 0
    v_mov_b64 v[2:3], 0
    v_mov_b64 v[4:5], 0
    v_mov_b64 v[6:7], 0
    v_mov_b64 v[8:9], 0
    v_mov_b64 v[10:11], 0
    v_mov_b64 v[12:13], 0
    v_mov_b64 v[14:15], 0
    v_mov_b64 v[16:17], 0
    v_mov_b64 v[18:19], 0
    v_mov_b64 v[20:21], 0
    v_mov_b64 v[22:23], 0
    v_mov_b64 v[24:25], 0
    v_mov_b64 v[26:27], 0
    v_mov_b64 v[28:29], 0
    v_mov_b64 v[30:31], 0
    v_mov_b64 v[32:33], 0
    v_mov_b64 v[34:35], 0
    v_mov_b64 v[36:37], 0
    v_mov_b64 v[38:39], 0
    v_mov_b64 v[40:41], 0
    v_mov_b64 v[42:43], 0
    v_mov_b64 v[44:45], 0
    v_mov_b64 v[46:47], 0
    v_mov_b64 v[48:49], 0
    v_mov_b64 v[50:51], 0
    v_mov_b64 v[52:53], 0
    v_mov_b64 v[54:55], 0
    v_mov_b64 v[56:57], 0
    v_mov_b64 v[58:59], 0
    v_mov_b64 v[60:61], 0
    v_mov_b64 v[62:63], 0
    v_mov_b64 v[208:209], 0
    v_mov_b64 v[210:211], 0
    v_mov_b64 v[212:213], 0
    v_mov_b64 v[214:215], 0
    s_mov_b32 s79, 0xffff0000
    v_mov_b32 v224, 0x3f803f80
    v_mov_b32 v225, 0x3f803f80
    v_mov_b32 v226, 0x3f803f80
    v_mov_b32 v227, 0x3f803f80
    s_add_u32 s72, s71, 131072
    v_add_u32 v128, s72, v228
    v_add_u32 v132, 114688, v228
    v_add_u32 v129, s72, v229
    v_add_u32 v133, 114688, v229
    v_add_u32 v130, s72, v230
    v_add_u32 v134, 114688, v230
    v_add_u32 v131, s72, v231
    v_add_u32 v135, 114688, v231
    s_mov_b32 s77, 0x3e0293ee
    s_mov_b32 s78, 0xceabfb8f
    s_barrier
    ds_read_b128 v[64:67], v128 offset:0
    ds_read_b128 v[68:71], v128 offset:4096
    ds_read_b128 v[72:75], v129 offset:0
    ds_read_b128 v[76:79], v129 offset:4096
    ds_read_b128 v[80:83], v130 offset:0
    ds_read_b128 v[84:87], v130 offset:4096
    ds_read_b128 v[88:91], v131 offset:0
    ds_read_b128 v[92:95], v131 offset:4096
    s_waitcnt lgkmcnt(7)
    v_lshlrev_b32 v240, 16, v64
    v_and_b32 v241, s79, v64
    v_mul_f32 v240, s77, v240
    v_mul_f32 v241, s77, v241
    v_cvt_pk_bf16_f32 v144, v240, v241
    v_lshlrev_b32 v242, 16, v65
    v_and_b32 v243, s79, v65
    v_mul_f32 v242, s77, v242
    v_mul_f32 v243, s77, v243
    v_cvt_pk_bf16_f32 v145, v242, v243
    v_lshlrev_b32 v240, 16, v66
    v_and_b32 v241, s79, v66
    v_mul_f32 v240, s77, v240
    v_mul_f32 v241, s77, v241
    v_cvt_pk_bf16_f32 v146, v240, v241
    v_lshlrev_b32 v242, 16, v67
    v_and_b32 v243, s79, v67
    v_mul_f32 v242, s77, v242
    v_mul_f32 v243, s77, v243
    v_cvt_pk_bf16_f32 v147, v242, v243
    s_waitcnt lgkmcnt(6)
    v_lshlrev_b32 v240, 16, v68
    v_and_b32 v241, s79, v68
    v_mul_f32 v240, s77, v240
    v_mul_f32 v241, s77, v241
    v_cvt_pk_bf16_f32 v148, v240, v241
    v_lshlrev_b32 v242, 16, v69
    v_and_b32 v243, s79, v69
    v_mul_f32 v242, s77, v242
    v_mul_f32 v243, s77, v243
    v_cvt_pk_bf16_f32 v149, v242, v243
    v_lshlrev_b32 v240, 16, v70
    v_and_b32 v241, s79, v70
    v_mul_f32 v240, s77, v240
    v_mul_f32 v241, s77, v241
    v_cvt_pk_bf16_f32 v150, v240, v241
    v_lshlrev_b32 v242, 16, v71
    v_and_b32 v243, s79, v71
    v_mul_f32 v242, s77, v242
    v_mul_f32 v243, s77, v243
    v_cvt_pk_bf16_f32 v151, v242, v243
    s_waitcnt lgkmcnt(5)
    v_lshlrev_b32 v240, 16, v72
    v_and_b32 v241, s79, v72
    v_mul_f32 v240, s77, v240
    v_mul_f32 v241, s77, v241
    v_cvt_pk_bf16_f32 v152, v240, v241
    v_lshlrev_b32 v242, 16, v73
    v_and_b32 v243, s79, v73
    v_mul_f32 v242, s77, v242
    v_mul_f32 v243, s77, v243
    v_cvt_pk_bf16_f32 v153, v242, v243
    v_lshlrev_b32 v240, 16, v74
    v_and_b32 v241, s79, v74
    v_mul_f32 v240, s77, v240
    v_mul_f32 v241, s77, v241
    v_cvt_pk_bf16_f32 v154, v240, v241
    v_lshlrev_b32 v242, 16, v75
    v_and_b32 v243, s79, v75
    v_mul_f32 v242, s77, v242
    v_mul_f32 v243, s77, v243
    v_cvt_pk_bf16_f32 v155, v242, v243
    s_waitcnt lgkmcnt(4)
    v_lshlrev_b32 v240, 16, v76
    v_and_b32 v241, s79, v76
    v_mul_f32 v240, s77, v240
    v_mul_f32 v241, s77, v241
    v_cvt_pk_bf16_f32 v156, v240, v241
    v_lshlrev_b32 v242, 16, v77
    v_and_b32 v243, s79, v77
    v_mul_f32 v242, s77, v242
    v_mul_f32 v243, s77, v243
    v_cvt_pk_bf16_f32 v157, v242, v243
    v_lshlrev_b32 v240, 16, v78
    v_and_b32 v241, s79, v78
    v_mul_f32 v240, s77, v240
    v_mul_f32 v241, s77, v241
    v_cvt_pk_bf16_f32 v158, v240, v241
    v_lshlrev_b32 v242, 16, v79
    v_and_b32 v243, s79, v79
    v_mul_f32 v242, s77, v242
    v_mul_f32 v243, s77, v243
    v_cvt_pk_bf16_f32 v159, v242, v243
    s_waitcnt lgkmcnt(3)
    v_lshlrev_b32 v240, 16, v80
    v_and_b32 v241, s79, v80
    v_mul_f32 v240, s77, v240
    v_mul_f32 v241, s77, v241
    v_cvt_pk_bf16_f32 v160, v240, v241
    v_lshlrev_b32 v242, 16, v81
    v_and_b32 v243, s79, v81
    v_mul_f32 v242, s77, v242
    v_mul_f32 v243, s77, v243
    v_cvt_pk_bf16_f32 v161, v242, v243
    v_lshlrev_b32 v240, 16, v82
    v_and_b32 v241, s79, v82
    v_mul_f32 v240, s77, v240
    v_mul_f32 v241, s77, v241
    v_cvt_pk_bf16_f32 v162, v240, v241
    v_lshlrev_b32 v242, 16, v83
    v_and_b32 v243, s79, v83
    v_mul_f32 v242, s77, v242
    v_mul_f32 v243, s77, v243
    v_cvt_pk_bf16_f32 v163, v242, v243
    s_waitcnt lgkmcnt(2)
    v_lshlrev_b32 v240, 16, v84
    v_and_b32 v241, s79, v84
    v_mul_f32 v240, s77, v240
    v_mul_f32 v241, s77, v241
    v_cvt_pk_bf16_f32 v164, v240, v241
    v_lshlrev_b32 v242, 16, v85
    v_and_b32 v243, s79, v85
    v_mul_f32 v242, s77, v242
    v_mul_f32 v243, s77, v243
    v_cvt_pk_bf16_f32 v165, v242, v243
    v_lshlrev_b32 v240, 16, v86
    v_and_b32 v241, s79, v86
    v_mul_f32 v240, s77, v240
    v_mul_f32 v241, s77, v241
    v_cvt_pk_bf16_f32 v166, v240, v241
    v_lshlrev_b32 v242, 16, v87
    v_and_b32 v243, s79, v87
    v_mul_f32 v242, s77, v242
    v_mul_f32 v243, s77, v243
    v_cvt_pk_bf16_f32 v167, v242, v243
    s_waitcnt lgkmcnt(1)
    v_lshlrev_b32 v240, 16, v88
    v_and_b32 v241, s79, v88
    v_mul_f32 v240, s77, v240
    v_mul_f32 v241, s77, v241
    v_cvt_pk_bf16_f32 v168, v240, v241
    v_lshlrev_b32 v242, 16, v89
    v_and_b32 v243, s79, v89
    v_mul_f32 v242, s77, v242
    v_mul_f32 v243, s77, v243
    v_cvt_pk_bf16_f32 v169, v242, v243
    v_lshlrev_b32 v240, 16, v90
    v_and_b32 v241, s79, v90
    v_mul_f32 v240, s77, v240
    v_mul_f32 v241, s77, v241
    v_cvt_pk_bf16_f32 v170, v240, v241
    v_lshlrev_b32 v242, 16, v91
    v_and_b32 v243, s79, v91
    v_mul_f32 v242, s77, v242
    v_mul_f32 v243, s77, v243
    v_cvt_pk_bf16_f32 v171, v242, v243
    s_waitcnt lgkmcnt(0)
    v_lshlrev_b32 v240, 16, v92
    v_and_b32 v241, s79, v92
    v_mul_f32 v240, s77, v240
    v_mul_f32 v241, s77, v241
    v_cvt_pk_bf16_f32 v172, v240, v241
    v_lshlrev_b32 v242, 16, v93
    v_and_b32 v243, s79, v93
    v_mul_f32 v242, s77, v242
    v_mul_f32 v243, s77, v243
    v_cvt_pk_bf16_f32 v173, v242, v243
    v_lshlrev_b32 v240, 16, v94
    v_and_b32 v241, s79, v94
    v_mul_f32 v240, s77, v240
    v_mul_f32 v241, s77, v241
    v_cvt_pk_bf16_f32 v174, v240, v241
    v_lshlrev_b32 v242, 16, v95
    v_and_b32 v243, s79, v95
    v_mul_f32 v242, s77, v242
    v_mul_f32 v243, s77, v243
    v_cvt_pk_bf16_f32 v175, v242, v243
    s_waitcnt vmcnt(2)
    v_lshlrev_b32 v216, 16, v252
    v_and_b32 v217, 0xffff0000, v252
    v_lshlrev_b32 v218, 16, v253
    v_and_b32 v219, 0xffff0000, v253
    v_sub_f32 v216, 1.0, v216
    v_mul_f32 v216, s78, v216
    v_sub_f32 v217, 1.0, v217
    v_mul_f32 v217, s78, v217
    v_sub_f32 v218, 1.0, v218
    v_mul_f32 v218, s78, v218
    v_sub_f32 v219, 1.0, v219
    v_mul_f32 v219, s78, v219
    s_barrier
    ds_read_b128 v[176:179], v228 offset:0
    ds_read_b128 v[180:183], v228 offset:4096
    ds_read_b128 v[184:187], v228 offset:8192
    ds_read_b128 v[188:191], v228 offset:12288
    s_waitcnt lgkmcnt(3)
    v_mfma_f32_16x16x32_bf16 v[64:67], v[176:179], v[144:147], 0
    ds_read_b128 v[192:195], v229 offset:0
    v_mfma_f32_16x16x32_bf16 v[68:71], v[176:179], v[148:151], 0
    s_waitcnt lgkmcnt(3)
    v_mfma_f32_16x16x32_bf16 v[76:79], v[180:183], v[148:151], 0
    ds_read_b128 v[196:199], v229 offset:4096
    v_mfma_f32_16x16x32_bf16 v[72:75], v[180:183], v[144:147], 0
    s_waitcnt lgkmcnt(3)
    v_mfma_f32_16x16x32_bf16 v[80:83], v[184:187], v[144:147], 0
    ds_read_b128 v[200:203], v229 offset:8192
    v_mfma_f32_16x16x32_bf16 v[84:87], v[184:187], v[148:151], 0
    s_waitcnt lgkmcnt(3)
    v_mfma_f32_16x16x32_bf16 v[92:95], v[188:191], v[148:151], 0
    ds_read_b128 v[204:207], v229 offset:12288
    v_mfma_f32_16x16x32_bf16 v[88:91], v[188:191], v[144:147], 0
    s_waitcnt lgkmcnt(3)
    v_mfma_f32_16x16x32_bf16 v[64:67], v[192:195], v[152:155], v[64:67]
    ds_read_b128 v[176:179], v230 offset:0
    v_mfma_f32_16x16x32_bf16 v[68:71], v[192:195], v[156:159], v[68:71]
    s_waitcnt lgkmcnt(3)
    v_mfma_f32_16x16x32_bf16 v[76:79], v[196:199], v[156:159], v[76:79]
    ds_read_b128 v[180:183], v230 offset:4096
    v_mfma_f32_16x16x32_bf16 v[72:75], v[196:199], v[152:155], v[72:75]
    s_waitcnt lgkmcnt(3)
    v_mfma_f32_16x16x32_bf16 v[80:83], v[200:203], v[152:155], v[80:83]
    ds_read_b128 v[184:187], v230 offset:8192
    v_mfma_f32_16x16x32_bf16 v[84:87], v[200:203], v[156:159], v[84:87]
    s_waitcnt lgkmcnt(3)
    v_mfma_f32_16x16x32_bf16 v[92:95], v[204:207], v[156:159], v[92:95]
    ds_read_b128 v[188:191], v230 offset:12288
    v_mfma_f32_16x16x32_bf16 v[88:91], v[204:207], v[152:155], v[88:91]
    s_waitcnt lgkmcnt(3)
    v_mfma_f32_16x16x32_bf16 v[64:67], v[176:179], v[160:163], v[64:67]
    ds_read_b128 v[192:195], v231 offset:0
    v_mfma_f32_16x16x32_bf16 v[68:71], v[176:179], v[164:167], v[68:71]
    s_waitcnt lgkmcnt(3)
    v_mfma_f32_16x16x32_bf16 v[76:79], v[180:183], v[164:167], v[76:79]
    ds_read_b128 v[196:199], v231 offset:4096
    v_mfma_f32_16x16x32_bf16 v[72:75], v[180:183], v[160:163], v[72:75]
    s_waitcnt lgkmcnt(3)
    v_mfma_f32_16x16x32_bf16 v[80:83], v[184:187], v[160:163], v[80:83]
    ds_read_b128 v[200:203], v231 offset:8192
    v_mfma_f32_16x16x32_bf16 v[84:87], v[184:187], v[164:167], v[84:87]
    s_waitcnt lgkmcnt(3)
    v_mfma_f32_16x16x32_bf16 v[92:95], v[188:191], v[164:167], v[92:95]
    ds_read_b128 v[204:207], v231 offset:12288
    v_mfma_f32_16x16x32_bf16 v[88:91], v[188:191], v[160:163], v[88:91]
    s_waitcnt lgkmcnt(3)
    v_mfma_f32_16x16x32_bf16 v[64:67], v[192:195], v[168:171], v[64:67]
    v_mfma_f32_16x16x32_bf16 v[68:71], v[192:195], v[172:175], v[68:71]
    s_waitcnt lgkmcnt(2)
    v_mfma_f32_16x16x32_bf16 v[76:79], v[196:199], v[172:175], v[76:79]
    v_mfma_f32_16x16x32_bf16 v[72:75], v[196:199], v[168:171], v[72:75]
    s_waitcnt lgkmcnt(1)
    v_mfma_f32_16x16x32_bf16 v[80:83], v[200:203], v[168:171], v[80:83]
    v_mfma_f32_16x16x32_bf16 v[84:87], v[200:203], v[172:175], v[84:87]
    s_waitcnt lgkmcnt(0)
    v_mfma_f32_16x16x32_bf16 v[92:95], v[204:207], v[172:175], v[92:95]
    v_mfma_f32_16x16x32_bf16 v[88:91], v[204:207], v[168:171], v[88:91]
    s_cmp_eq_u32 s68, 0
    s_cbranch_scc1 L_notree0
    ds_read_b128 v[176:179], v132
    ds_read_b128 v[180:183], v133
    ds_read_b128 v[184:187], v134
    ds_read_b128 v[188:191], v135
    s_waitcnt lgkmcnt(3)
    v_mfma_f32_16x16x32_bf16 v[96:99], v[176:179], v[144:147], v[216:219]
    v_mfma_f32_16x16x32_bf16 v[100:103], v[176:179], v[148:151], v[216:219]
    s_waitcnt lgkmcnt(2)
    v_mfma_f32_16x16x32_bf16 v[96:99], v[180:183], v[152:155], v[96:99]
    v_mfma_f32_16x16x32_bf16 v[100:103], v[180:183], v[156:159], v[100:103]
    s_waitcnt lgkmcnt(1)
    v_mfma_f32_16x16x32_bf16 v[96:99], v[184:187], v[160:163], v[96:99]
    v_mfma_f32_16x16x32_bf16 v[100:103], v[184:187], v[164:167], v[100:103]
    s_waitcnt lgkmcnt(0)
    v_mfma_f32_16x16x32_bf16 v[96:99], v[188:191], v[168:171], v[96:99]
    v_mfma_f32_16x16x32_bf16 v[100:103], v[188:191], v[172:175], v[100:103]
    s_branch L_tree1
L_notree0:
    v_mov_b32 v96, 0xff800000
    v_mov_b32 v97, 0xff800000
    v_mov_b32 v98, 0xff800000
    v_mov_b32 v99, 0xff800000
    v_mov_b32 v100, 0xff800000
    v_mov_b32 v101, 0xff800000
    v_mov_b32 v102, 0xff800000
    v_mov_b32 v103, 0xff800000
L_tree1:
    v_max3_f32 v240, v64, v65, v66
    v_max3_f32 v240, v240, v67, v72
    v_max3_f32 v240, v240, v73, v74
    v_max3_f32 v240, v240, v75, v80
    v_max3_f32 v240, v240, v81, v82
    v_max3_f32 v240, v240, v83, v88
    v_max3_f32 v240, v240, v89, v90
    v_max3_f32 v240, v240, v91, v96
    v_max3_f32 v240, v240, v97, v98
    v_max_f32 v240, v240, v99
    v_mov_b32 v241, v240
    s_nop 1
    v_permlane16_swap_b32 v240, v241
    v_max_f32 v240, v240, v241
    v_mov_b32 v241, v240
    s_nop 1
    v_permlane32_swap_b32 v240, v241
    v_max_f32 v240, v240, v241
    v_sub_f32 v64, v64, v240
    v_sub_f32 v65, v65, v240
    v_sub_f32 v66, v66, v240
    v_sub_f32 v67, v67, v240
    v_sub_f32 v72, v72, v240
    v_sub_f32 v73, v73, v240
    v_sub_f32 v74, v74, v240
    v_sub_f32 v75, v75, v240
    v_sub_f32 v80, v80, v240
    v_sub_f32 v81, v81, v240
    v_sub_f32 v82, v82, v240
    v_sub_f32 v83, v83, v240
    v_sub_f32 v88, v88, v240
    v_sub_f32 v89, v89, v240
    v_sub_f32 v90, v90, v240
    v_sub_f32 v91, v91, v240
    v_sub_f32 v96, v96, v240
    v_sub_f32 v97, v97, v240
    v_sub_f32 v98, v98, v240
    v_sub_f32 v99, v99, v240
    v_sub_f32 v216, 0, v240
    v_sub_f32 v217, 0, v240
    v_sub_f32 v218, 0, v240
    v_sub_f32 v219, 0, v240
    v_max3_f32 v240, v68, v69, v70
    v_max3_f32 v240, v240, v71, v76
    v_max3_f32 v240, v240, v77, v78
    v_max3_f32 v240, v240, v79, v84
    v_max3_f32 v240, v240, v85, v86
    v_max3_f32 v240, v240, v87, v92
    v_max3_f32 v240, v240, v93, v94
    v_max3_f32 v240, v240, v95, v100
    v_max3_f32 v240, v240, v101, v102
    v_max_f32 v240, v240, v103
    v_mov_b32 v241, v240
    s_nop 1
    v_permlane16_swap_b32 v240, v241
    v_max_f32 v240, v240, v241
    v_mov_b32 v241, v240
    s_nop 1
    v_permlane32_swap_b32 v240, v241
    v_max_f32 v240, v240, v241
    v_sub_f32 v68, v68, v240
    v_sub_f32 v69, v69, v240
    v_sub_f32 v70, v70, v240
    v_sub_f32 v71, v71, v240
    v_sub_f32 v76, v76, v240
    v_sub_f32 v77, v77, v240
    v_sub_f32 v78, v78, v240
    v_sub_f32 v79, v79, v240
    v_sub_f32 v84, v84, v240
    v_sub_f32 v85, v85, v240
    v_sub_f32 v86, v86, v240
    v_sub_f32 v87, v87, v240
    v_sub_f32 v92, v92, v240
    v_sub_f32 v93, v93, v240
    v_sub_f32 v94, v94, v240
    v_sub_f32 v95, v95, v240
    v_sub_f32 v100, v100, v240
    v_sub_f32 v101, v101, v240
    v_sub_f32 v102, v102, v240
    v_sub_f32 v103, v103, v240
    v_sub_f32 v220, 0, v240
    v_sub_f32 v221, 0, v240
    v_sub_f32 v222, 0, v240
    v_sub_f32 v223, 0, v240
    s_cmp_eq_u32 s68, 0
    s_cbranch_scc1 L_notree2
    ds_read_b64_tr_b16 v[176:177], v232 offset:53248
    ds_read_b64_tr_b16 v[178:179], v233 offset:53248
    ds_read_b64_tr_b16 v[180:181], v234 offset:53248
    ds_read_b64_tr_b16 v[182:183], v235 offset:53248
    ds_read_b64_tr_b16 v[184:185], v236 offset:53248
    ds_read_b64_tr_b16 v[186:187], v237 offset:53248
    ds_read_b64_tr_b16 v[188:189], v238 offset:53248
    ds_read_b64_tr_b16 v[190:191], v239 offset:53248
    v_exp_f32 v96, v96
    v_exp_f32 v97, v97
    v_exp_f32 v98, v98
    v_exp_f32 v99, v99
    v_exp_f32 v100, v100
    v_exp_f32 v101, v101
    v_exp_f32 v102, v102
    v_exp_f32 v103, v103
    v_cvt_pk_bf16_f32 v128, v96, v97
    v_cvt_pk_bf16_f32 v129, v98, v99
    v_cvt_pk_bf16_f32 v130, v100, v101
    v_cvt_pk_bf16_f32 v131, v102, v103
    v_mfma_f32_16x16x16_bf16 v[208:211], v[224:225], v[128:129], v[208:211]
    s_nop 0
    v_mfma_f32_16x16x16_bf16 v[212:215], v[224:225], v[130:131], v[212:215]
    s_waitcnt lgkmcnt(7)
    v_mfma_f32_16x16x16_bf16 v[0:3], v[176:177], v[128:129], v[0:3]
    v_mfma_f32_16x16x16_bf16 v[4:7], v[176:177], v[130:131], v[4:7]
    s_waitcnt lgkmcnt(6)
    v_mfma_f32_16x16x16_bf16 v[8:11], v[178:179], v[128:129], v[8:11]
    v_mfma_f32_16x16x16_bf16 v[12:15], v[178:179], v[130:131], v[12:15]
    s_waitcnt lgkmcnt(5)
    v_mfma_f32_16x16x16_bf16 v[16:19], v[180:181], v[128:129], v[16:19]
    v_mfma_f32_16x16x16_bf16 v[20:23], v[180:181], v[130:131], v[20:23]
    s_waitcnt lgkmcnt(4)
    v_mfma_f32_16x16x16_bf16 v[24:27], v[182:183], v[128:129], v[24:27]
    v_mfma_f32_16x16x16_bf16 v[28:31], v[182:183], v[130:131], v[28:31]
    s_waitcnt lgkmcnt(3)
    v_mfma_f32_16x16x16_bf16 v[32:35], v[184:185], v[128:129], v[32:35]
    v_mfma_f32_16x16x16_bf16 v[36:39], v[184:185], v[130:131], v[36:39]
    s_waitcnt lgkmcnt(2)
    v_mfma_f32_16x16x16_bf16 v[40:43], v[186:187], v[128:129], v[40:43]
    v_mfma_f32_16x16x16_bf16 v[44:47], v[186:187], v[130:131], v[44:47]
    s_waitcnt lgkmcnt(1)
    v_mfma_f32_16x16x16_bf16 v[48:51], v[188:189], v[128:129], v[48:51]
    v_mfma_f32_16x16x16_bf16 v[52:55], v[188:189], v[130:131], v[52:55]
    s_waitcnt lgkmcnt(0)
    v_mfma_f32_16x16x16_bf16 v[56:59], v[190:191], v[128:129], v[56:59]
    v_mfma_f32_16x16x16_bf16 v[60:63], v[190:191], v[130:131], v[60:63]
L_notree2:
    v_exp_f32 v64, v64
    v_exp_f32 v65, v65
    v_exp_f32 v66, v66
    v_cvt_pk_bf16_f32 v128, v64, v65
    v_exp_f32 v67, v67
    v_exp_f32 v72, v72
    v_cvt_pk_bf16_f32 v129, v66, v67
    v_exp_f32 v73, v73
    v_exp_f32 v74, v74
    v_cvt_pk_bf16_f32 v130, v72, v73
    v_exp_f32 v75, v75
    v_exp_f32 v68, v68
    v_cvt_pk_bf16_f32 v131, v74, v75
    v_exp_f32 v69, v69
    v_exp_f32 v70, v70
    v_cvt_pk_bf16_f32 v132, v68, v69
    v_exp_f32 v71, v71
    v_exp_f32 v76, v76
    v_cvt_pk_bf16_f32 v133, v70, v71
    v_exp_f32 v77, v77
    s_nop 0
    v_cvt_pk_bf16_f32 v134, v76, v77
    s_waitcnt vmcnt(0)
    v_readfirstlane_b32 s6, v254
    v_readfirstlane_b32 s7, v255
    v_lshlrev_b32 v240, 4, v250
    v_and_b32 v254, 0xff, v240
    v_lshrrev_b32 v241, 3, v250
    v_lshl_add_u32 v253, v241, 7, v240
    v_lshrrev_b32 v240, 2, v250
    v_lshlrev_b32 v241, 7, v240
    v_and_b32 v242, 1, v250
    v_lshl_add_u32 v241, v242, 3, v241
    v_add_u32 v241, 98304, v241
    v_and_b32 v240, 6, v240
    v_bfe_u32 v242, v250, 1, 1
    v_or_b32 v240, v240, v242
    v_xor_b32 v242, 0, v240
    v_lshl_add_u32 v244, v242, 4, v241
    v_xor_b32 v242, 2, v240
    v_lshl_add_u32 v245, v242, 4, v241
    v_xor_b32 v242, 4, v240
    v_lshl_add_u32 v246, v242, 4, v241
    v_xor_b32 v242, 6, v240
    v_lshl_add_u32 v247, v242, 4, v241
    s_getreg_b32 s9, hwreg(HW_REG_XCC_ID, 0, 4)
    s_lshr_b32 s6, s6, 4
    s_and_b32 s7, s7, -16
    s_or_b32 s7, s7, s9
    s_mov_b32 s66, 4
L_loop:
    s_barrier
    ds_read_b128 v[176:179], v228 offset:16384
    ds_read_b128 v[180:183], v228 offset:20480
    ds_read_b128 v[184:187], v228 offset:24576
    ds_read_b128 v[188:191], v228 offset:28672
    v_exp_f32 v78, v78
    v_exp_f32 v79, v79
    s_waitcnt lgkmcnt(2)
    v_mfma_f32_16x16x32_bf16 v[96:99], v[176:179], v[144:147], v[216:219]
    ds_read_b128 v[192:195], v229 offset:16384
    v_mfma_f32_16x16x32_bf16 v[100:103], v[176:179], v[148:151], v[220:223]
    v_mfma_f32_16x16x32_bf16 v[108:111], v[180:183], v[148:151], v[220:223]
    ds_read_b128 v[196:199], v229 offset:20480
    s_waitcnt lgkmcnt(2)
    v_mfma_f32_16x16x32_bf16 v[104:107], v[180:183], v[144:147], v[216:219]
    v_mfma_f32_16x16x32_bf16 v[112:115], v[184:187], v[144:147], v[216:219]
    ds_read_b128 v[200:203], v229 offset:24576
    v_mfma_f32_16x16x32_bf16 v[116:119], v[184:187], v[148:151], v[220:223]
    v_exp_f32 v80, v80
    v_mfma_f32_16x16x32_bf16 v[124:127], v[188:191], v[148:151], v[220:223]
    ds_read_b128 v[204:207], v229 offset:28672
    s_waitcnt lgkmcnt(2)
    v_mfma_f32_16x16x32_bf16 v[120:123], v[188:191], v[144:147], v[216:219]
    v_exp_f32 v81, v81
    v_cvt_pk_bf16_f32 v135, v78, v79
    v_mfma_f32_16x16x32_bf16 v[96:99], v[192:195], v[152:155], v[96:99]
    ds_read_b128 v[176:179], v230 offset:16384
    v_cvt_pk_bf16_f32 v136, v80, v81
    v_mfma_f32_16x16x32_bf16 v[100:103], v[192:195], v[156:159], v[100:103]
    v_exp_f32 v82, v82
    v_exp_f32 v83, v83
    v_mfma_f32_16x16x32_bf16 v[108:111], v[196:199], v[156:159], v[108:111]
    ds_read_b128 v[180:183], v230 offset:20480
    s_waitcnt lgkmcnt(2)
    v_mfma_f32_16x16x32_bf16 v[104:107], v[196:199], v[152:155], v[104:107]
    v_exp_f32 v88, v88
    v_mfma_f32_16x16x32_bf16 v[112:115], v[200:203], v[152:155], v[112:115]
    ds_read_b128 v[184:187], v230 offset:24576
    v_cvt_pk_bf16_f32 v137, v82, v83
    v_mfma_f32_16x16x32_bf16 v[116:119], v[200:203], v[156:159], v[116:119]
    v_exp_f32 v89, v89
    v_exp_f32 v90, v90
    v_mfma_f32_16x16x32_bf16 v[124:127], v[204:207], v[156:159], v[124:127]
    ds_read_b128 v[188:191], v230 offset:28672
    s_waitcnt lgkmcnt(2)
    v_mfma_f32_16x16x32_bf16 v[120:123], v[204:207], v[152:155], v[120:123]
    v_exp_f32 v91, v91
    v_mfma_f32_16x16x32_bf16 v[96:99], v[176:179], v[160:163], v[96:99]
    ds_read_b128 v[192:195], v231 offset:16384
    v_cvt_pk_bf16_f32 v138, v88, v89
    v_mfma_f32_16x16x32_bf16 v[100:103], v[176:179], v[164:167], v[100:103]
    v_exp_f32 v84, v84
    v_mfma_f32_16x16x32_bf16 v[108:111], v[180:183], v[164:167], v[108:111]
    ds_read_b128 v[196:199], v231 offset:20480
    s_waitcnt lgkmcnt(2)
    v_mfma_f32_16x16x32_bf16 v[104:107], v[180:183], v[160:163], v[104:107]
    v_exp_f32 v85, v85
    v_cvt_pk_bf16_f32 v139, v90, v91
    v_mfma_f32_16x16x32_bf16 v[112:115], v[184:187], v[160:163], v[112:115]
    ds_read_b128 v[200:203], v231 offset:24576
    v_cvt_pk_bf16_f32 v140, v84, v85
    v_mfma_f32_16x16x32_bf16 v[116:119], v[184:187], v[164:167], v[116:119]
    v_exp_f32 v86, v86
    v_exp_f32 v87, v87
    v_mfma_f32_16x16x32_bf16 v[124:127], v[188:191], v[164:167], v[124:127]
    ds_read_b128 v[204:207], v231 offset:28672
    s_waitcnt lgkmcnt(2)
    v_mfma_f32_16x16x32_bf16 v[120:123], v[188:191], v[160:163], v[120:123]
    v_exp_f32 v92, v92
    v_mfma_f32_16x16x32_bf16 v[96:99], v[192:195], v[168:171], v[96:99]
    ds_read_b64_tr_b16 v[176:177], v232 offset:0
    ds_read_b64_tr_b16 v[178:179], v232 offset:4096
    v_mfma_f32_16x16x32_bf16 v[100:103], v[192:195], v[172:175], v[100:103]
    v_exp_f32 v93, v93
    v_mfma_f32_16x16x32_bf16 v[108:111], v[196:199], v[172:175], v[108:111]
    ds_read_b64_tr_b16 v[180:181], v233 offset:0
    v_cvt_pk_bf16_f32 v141, v86, v87
    v_cvt_pk_bf16_f32 v142, v92, v93
    v_mfma_f32_16x16x32_bf16 v[104:107], v[196:199], v[168:171], v[104:107]
    ds_read_b64_tr_b16 v[182:183], v233 offset:4096
    s_waitcnt lgkmcnt(4)
    v_mfma_f32_16x16x32_bf16 v[112:115], v[200:203], v[168:171], v[112:115]
    ds_read_b64_tr_b16 v[184:185], v234 offset:0
    ds_read_b64_tr_b16 v[186:187], v234 offset:4096
    v_mfma_f32_16x16x32_bf16 v[116:119], v[200:203], v[172:175], v[116:119]
    v_exp_f32 v94, v94
    v_mfma_f32_16x16x32_bf16 v[124:127], v[204:207], v[172:175], v[124:127]
    ds_read_b64_tr_b16 v[188:189], v235 offset:0
    v_exp_f32 v95, v95
    v_mfma_f32_16x16x32_bf16 v[120:123], v[204:207], v[168:171], v[120:123]
    ds_read_b64_tr_b16 v[190:191], v235 offset:4096
    v_cvt_pk_bf16_f32 v143, v94, v95
    s_waitcnt lgkmcnt(4)
    v_mfma_f32_16x16x32_bf16 v[0:3], v[176:179], v[128:131], v[0:3]
    ds_read_b64_tr_b16 v[192:193], v236 offset:0
    v_mfma_f32_16x16x32_bf16 v[4:7], v[176:179], v[132:135], v[4:7]
    ds_read_b64_tr_b16 v[194:195], v236 offset:4096
    v_mfma_f32_16x16x32_bf16 v[12:15], v[180:183], v[132:135], v[12:15]
    ds_read_b64_tr_b16 v[196:197], v237 offset:0
    v_max3_f32 v240, v96, v97, v98
    v_mfma_f32_16x16x32_bf16 v[8:11], v[180:183], v[128:131], v[8:11]
    ds_read_b64_tr_b16 v[198:199], v237 offset:4096
    s_waitcnt lgkmcnt(4)
    v_mfma_f32_16x16x32_bf16 v[16:19], v[184:187], v[128:131], v[16:19]
    ds_read_b64_tr_b16 v[200:201], v238 offset:0
    v_max3_f32 v240, v240, v99, v100
    v_mfma_f32_16x16x32_bf16 v[20:23], v[184:187], v[132:135], v[20:23]
    ds_read_b64_tr_b16 v[202:203], v238 offset:4096
    v_max3_f32 v240, v240, v101, v102
    v_mfma_f32_16x16x32_bf16 v[28:31], v[188:191], v[132:135], v[28:31]
    ds_read_b64_tr_b16 v[204:205], v239 offset:0
    v_max3_f32 v240, v240, v103, v104
    v_mfma_f32_16x16x32_bf16 v[24:27], v[188:191], v[128:131], v[24:27]
    ds_read_b64_tr_b16 v[206:207], v239 offset:4096
    s_waitcnt lgkmcnt(4)
    v_mfma_f32_16x16x32_bf16 v[32:35], v[192:195], v[128:131], v[32:35]
    ds_read_b64_tr_b16 v[176:177], v232 offset:8192
    v_max3_f32 v240, v240, v105, v106
    v_mfma_f32_16x16x32_bf16 v[36:39], v[192:195], v[132:135], v[36:39]
    ds_read_b64_tr_b16 v[178:179], v232 offset:12288
    v_max3_f32 v240, v240, v107, v108
    v_mfma_f32_16x16x32_bf16 v[44:47], v[196:199], v[132:135], v[44:47]
    ds_read_b64_tr_b16 v[180:181], v233 offset:8192
    v_max3_f32 v240, v240, v109, v110
    v_mfma_f32_16x16x32_bf16 v[40:43], v[196:199], v[128:131], v[40:43]
    ds_read_b64_tr_b16 v[182:183], v233 offset:12288
    s_waitcnt lgkmcnt(4)
    v_mfma_f32_16x16x32_bf16 v[48:51], v[200:203], v[128:131], v[48:51]
    ds_read_b64_tr_b16 v[184:185], v234 offset:8192
    v_max3_f32 v240, v240, v111, v112
    v_mfma_f32_16x16x32_bf16 v[52:55], v[200:203], v[132:135], v[52:55]
    ds_read_b64_tr_b16 v[186:187], v234 offset:12288
    v_max3_f32 v240, v240, v113, v114
    v_mfma_f32_16x16x32_bf16 v[60:63], v[204:207], v[132:135], v[60:63]
    ds_read_b64_tr_b16 v[188:189], v235 offset:8192
    v_max3_f32 v240, v240, v115, v116
    v_max3_f32 v240, v240, v117, v118
    v_mfma_f32_16x16x32_bf16 v[56:59], v[204:207], v[128:131], v[56:59]
    ds_read_b64_tr_b16 v[190:191], v235 offset:12288
    v_max3_f32 v240, v240, v119, v120
    v_mfma_f32_16x16x32_bf16 v[208:211], v[224:227], v[128:131], v[208:211]
    v_max3_f32 v240, v240, v121, v122
    s_waitcnt lgkmcnt(4)
    v_mfma_f32_16x16x32_bf16 v[212:215], v[224:227], v[132:135], v[212:215]
    v_max3_f32 v240, v240, v123, v124
    v_max3_f32 v240, v240, v125, v126
    v_max_f32 v240, v240, v127
    v_cmp_lt_f32 vcc, s65, v240
    s_mov_b32 s80, 0
    s_cbranch_vccnz L_rescale1
L_ret1_0:
    v_mfma_f32_16x16x32_bf16 v[0:3], v[176:179], v[136:139], v[0:3]
    ds_read_b64_tr_b16 v[192:193], v236 offset:8192
    ds_read_b64_tr_b16 v[194:195], v236 offset:12288
    v_mfma_f32_16x16x32_bf16 v[4:7], v[176:179], v[140:143], v[4:7]
    v_exp_f32 v96, v96
    v_mfma_f32_16x16x32_bf16 v[12:15], v[180:183], v[140:143], v[12:15]
    ds_read_b64_tr_b16 v[196:197], v237 offset:8192
    v_exp_f32 v97, v97
    v_mfma_f32_16x16x32_bf16 v[8:11], v[180:183], v[136:139], v[8:11]
    ds_read_b64_tr_b16 v[198:199], v237 offset:12288
    s_waitcnt lgkmcnt(4)
    v_mfma_f32_16x16x32_bf16 v[16:19], v[184:187], v[136:139], v[16:19]
    ds_read_b64_tr_b16 v[200:201], v238 offset:8192
    ds_read_b64_tr_b16 v[202:203], v238 offset:12288
    v_mfma_f32_16x16x32_bf16 v[20:23], v[184:187], v[140:143], v[20:23]
    v_exp_f32 v98, v98
    v_mfma_f32_16x16x32_bf16 v[28:31], v[188:191], v[140:143], v[28:31]
    ds_read_b64_tr_b16 v[204:205], v239 offset:8192
    v_cvt_pk_bf16_f32 v128, v96, v97
    v_mfma_f32_16x16x32_bf16 v[24:27], v[188:191], v[136:139], v[24:27]
    ds_read_b64_tr_b16 v[206:207], v239 offset:12288
    s_waitcnt lgkmcnt(4)
    v_mfma_f32_16x16x32_bf16 v[32:35], v[192:195], v[136:139], v[32:35]
    v_exp_f32 v99, v99
    v_exp_f32 v104, v104
    v_mfma_f32_16x16x32_bf16 v[36:39], v[192:195], v[140:143], v[36:39]
    v_exp_f32 v105, v105
    v_mfma_f32_16x16x32_bf16 v[44:47], v[196:199], v[140:143], v[44:47]
    v_cvt_pk_bf16_f32 v129, v98, v99
    s_waitcnt lgkmcnt(0)
    v_mfma_f32_16x16x32_bf16 v[40:43], v[196:199], v[136:139], v[40:43]
    v_exp_f32 v106, v106
    v_cvt_pk_bf16_f32 v130, v104, v105
    v_mfma_f32_16x16x32_bf16 v[48:51], v[200:203], v[136:139], v[48:51]
    v_exp_f32 v107, v107
    v_mfma_f32_16x16x32_bf16 v[52:55], v[200:203], v[140:143], v[52:55]
    v_exp_f32 v100, v100
    v_cvt_pk_bf16_f32 v131, v106, v107
    v_mfma_f32_16x16x32_bf16 v[60:63], v[204:207], v[140:143], v[60:63]
    v_exp_f32 v101, v101
    v_exp_f32 v102, v102
    v_mfma_f32_16x16x32_bf16 v[56:59], v[204:207], v[136:139], v[56:59]
    v_exp_f32 v103, v103
    v_mfma_f32_16x16x32_bf16 v[208:211], v[224:227], v[136:139], v[208:211]
    v_exp_f32 v108, v108
    v_cvt_pk_bf16_f32 v132, v100, v101
    v_mfma_f32_16x16x32_bf16 v[212:215], v[224:227], v[140:143], v[212:215]
    v_exp_f32 v109, v109
    v_cvt_pk_bf16_f32 v133, v102, v103
    v_cvt_pk_bf16_f32 v134, v108, v109
    s_bitcmp1_b32 s66, 1
    s_cbranch_scc1 L_hello
L_hello_back:
    s_barrier
    ds_read_b128 v[176:179], v228 offset:32768
    ds_read_b128 v[180:183], v228 offset:36864
    ds_read_b128 v[184:187], v228 offset:40960
    ds_read_b128 v[188:191], v228 offset:45056
    v_exp_f32 v110, v110
    v_exp_f32 v111, v111
    s_waitcnt lgkmcnt(2)
    v_mfma_f32_16x16x32_bf16 v[64:67], v[176:179], v[144:147], v[216:219]
    ds_read_b128 v[192:195], v229 offset:32768
    v_mfma_f32_16x16x32_bf16 v[68:71], v[176:179], v[148:151], v[220:223]
    v_mfma_f32_16x16x32_bf16 v[76:79], v[180:183], v[148:151], v[220:223]
    ds_read_b128 v[196:199], v229 offset:36864
    s_waitcnt lgkmcnt(2)
    v_mfma_f32_16x16x32_bf16 v[72:75], v[180:183], v[144:147], v[216:219]
    v_mfma_f32_16x16x32_bf16 v[80:83], v[184:187], v[144:147], v[216:219]
    ds_read_b128 v[200:203], v229 offset:40960
    v_mfma_f32_16x16x32_bf16 v[84:87], v[184:187], v[148:151], v[220:223]
    v_exp_f32 v112, v112
    v_mfma_f32_16x16x32_bf16 v[92:95], v[188:191], v[148:151], v[220:223]
    ds_read_b128 v[204:207], v229 offset:45056
    s_waitcnt lgkmcnt(2)
    v_mfma_f32_16x16x32_bf16 v[88:91], v[188:191], v[144:147], v[216:219]
    v_exp_f32 v113, v113
    v_cvt_pk_bf16_f32 v135, v110, v111
    v_mfma_f32_16x16x32_bf16 v[64:67], v[192:195], v[152:155], v[64:67]
    ds_read_b128 v[176:179], v230 offset:32768
    v_cvt_pk_bf16_f32 v136, v112, v113
    v_mfma_f32_16x16x32_bf16 v[68:71], v[192:195], v[156:159], v[68:71]
    v_exp_f32 v114, v114
    v_exp_f32 v115, v115
    v_mfma_f32_16x16x32_bf16 v[76:79], v[196:199], v[156:159], v[76:79]
    ds_read_b128 v[180:183], v230 offset:36864
    s_waitcnt lgkmcnt(2)
    v_mfma_f32_16x16x32_bf16 v[72:75], v[196:199], v[152:155], v[72:75]
    v_exp_f32 v120, v120
    v_mfma_f32_16x16x32_bf16 v[80:83], v[200:203], v[152:155], v[80:83]
    ds_read_b128 v[184:187], v230 offset:40960
    v_cvt_pk_bf16_f32 v137, v114, v115
    v_mfma_f32_16x16x32_bf16 v[84:87], v[200:203], v[156:159], v[84:87]
    v_exp_f32 v121, v121
    v_exp_f32 v122, v122
    v_mfma_f32_16x16x32_bf16 v[92:95], v[204:207], v[156:159], v[92:95]
    ds_read_b128 v[188:191], v230 offset:45056
    s_waitcnt lgkmcnt(2)
    v_mfma_f32_16x16x32_bf16 v[88:91], v[204:207], v[152:155], v[88:91]
    v_exp_f32 v123, v123
    v_mfma_f32_16x16x32_bf16 v[64:67], v[176:179], v[160:163], v[64:67]
    ds_read_b128 v[192:195], v231 offset:32768
    v_cvt_pk_bf16_f32 v138, v120, v121
    v_mfma_f32_16x16x32_bf16 v[68:71], v[176:179], v[164:167], v[68:71]
    v_exp_f32 v116, v116
    v_mfma_f32_16x16x32_bf16 v[76:79], v[180:183], v[164:167], v[76:79]
    ds_read_b128 v[196:199], v231 offset:36864
    s_waitcnt lgkmcnt(2)
    v_mfma_f32_16x16x32_bf16 v[72:75], v[180:183], v[160:163], v[72:75]
    v_exp_f32 v117, v117
    v_cvt_pk_bf16_f32 v139, v122, v123
    v_mfma_f32_16x16x32_bf16 v[80:83], v[184:187], v[160:163], v[80:83]
    ds_read_b128 v[200:203], v231 offset:40960
    v_cvt_pk_bf16_f32 v140, v116, v117
    v_mfma_f32_16x16x32_bf16 v[84:87], v[184:187], v[164:167], v[84:87]
    v_exp_f32 v118, v118
    v_exp_f32 v119, v119
    v_mfma_f32_16x16x32_bf16 v[92:95], v[188:191], v[164:167], v[92:95]
    ds_read_b128 v[204:207], v231 offset:45056
    s_waitcnt lgkmcnt(2)
    v_mfma_f32_16x16x32_bf16 v[88:91], v[188:191], v[160:163], v[88:91]
    v_exp_f32 v124, v124
    v_mfma_f32_16x16x32_bf16 v[64:67], v[192:195], v[168:171], v[64:67]
    ds_read_b64_tr_b16 v[176:177], v232 offset:16384
    ds_read_b64_tr_b16 v[178:179], v232 offset:20480
    v_mfma_f32_16x16x32_bf16 v[68:71], v[192:195], v[172:175], v[68:71]
    v_exp_f32 v125, v125
    v_mfma_f32_16x16x32_bf16 v[76:79], v[196:199], v[172:175], v[76:79]
    ds_read_b64_tr_b16 v[180:181], v233 offset:16384
    v_cvt_pk_bf16_f32 v141, v118, v119
    v_cvt_pk_bf16_f32 v142, v124, v125
    v_mfma_f32_16x16x32_bf16 v[72:75], v[196:199], v[168:171], v[72:75]
    ds_read_b64_tr_b16 v[182:183], v233 offset:20480
    s_waitcnt lgkmcnt(4)
    v_mfma_f32_16x16x32_bf16 v[80:83], v[200:203], v[168:171], v[80:83]
    ds_read_b64_tr_b16 v[184:185], v234 offset:16384
    ds_read_b64_tr_b16 v[186:187], v234 offset:20480
    v_mfma_f32_16x16x32_bf16 v[84:87], v[200:203], v[172:175], v[84:87]
    v_exp_f32 v126, v126
    v_mfma_f32_16x16x32_bf16 v[92:95], v[204:207], v[172:175], v[92:95]
    ds_read_b64_tr_b16 v[188:189], v235 offset:16384
    v_exp_f32 v127, v127
    v_mfma_f32_16x16x32_bf16 v[88:91], v[204:207], v[168:171], v[88:91]
    ds_read_b64_tr_b16 v[190:191], v235 offset:20480
    v_cvt_pk_bf16_f32 v143, v126, v127
    s_waitcnt lgkmcnt(4)
    v_mfma_f32_16x16x32_bf16 v[0:3], v[176:179], v[128:131], v[0:3]
    ds_read_b64_tr_b16 v[192:193], v236 offset:16384
    v_mfma_f32_16x16x32_bf16 v[4:7], v[176:179], v[132:135], v[4:7]
    ds_read_b64_tr_b16 v[194:195], v236 offset:20480
    v_mfma_f32_16x16x32_bf16 v[12:15], v[180:183], v[132:135], v[12:15]
    ds_read_b64_tr_b16 v[196:197], v237 offset:16384
    v_max3_f32 v240, v64, v65, v66
    v_mfma_f32_16x16x32_bf16 v[8:11], v[180:183], v[128:131], v[8:11]
    ds_read_b64_tr_b16 v[198:199], v237 offset:20480
    s_waitcnt lgkmcnt(4)
    v_mfma_f32_16x16x32_bf16 v[16:19], v[184:187], v[128:131], v[16:19]
    ds_read_b64_tr_b16 v[200:201], v238 offset:16384
    v_max3_f32 v240, v240, v67, v68
    v_mfma_f32_16x16x32_bf16 v[20:23], v[184:187], v[132:135], v[20:23]
    ds_read_b64_tr_b16 v[202:203], v238 offset:20480
    v_max3_f32 v240, v240, v69, v70
    v_mfma_f32_16x16x32_bf16 v[28:31], v[188:191], v[132:135], v[28:31]
    ds_read_b64_tr_b16 v[204:205], v239 offset:16384
    v_max3_f32 v240, v240, v71, v72
    v_mfma_f32_16x16x32_bf16 v[24:27], v[188:191], v[128:131], v[24:27]
    ds_read_b64_tr_b16 v[206:207], v239 offset:20480
    s_waitcnt lgkmcnt(4)
    v_mfma_f32_16x16x32_bf16 v[32:35], v[192:195], v[128:131], v[32:35]
    ds_read_b64_tr_b16 v[176:177], v232 offset:24576
    v_max3_f32 v240, v240, v73, v74
    v_mfma_f32_16x16x32_bf16 v[36:39], v[192:195], v[132:135], v[36:39]
    ds_read_b64_tr_b16 v[178:179], v232 offset:28672
    v_max3_f32 v240, v240, v75, v76
    v_mfma_f32_16x16x32_bf16 v[44:47], v[196:199], v[132:135], v[44:47]
    ds_read_b64_tr_b16 v[180:181], v233 offset:24576
    v_max3_f32 v240, v240, v77, v78
    v_mfma_f32_16x16x32_bf16 v[40:43], v[196:199], v[128:131], v[40:43]
    ds_read_b64_tr_b16 v[182:183], v233 offset:28672
    s_waitcnt lgkmcnt(4)
    v_mfma_f32_16x16x32_bf16 v[48:51], v[200:203], v[128:131], v[48:51]
    ds_read_b64_tr_b16 v[184:185], v234 offset:24576
    v_max3_f32 v240, v240, v79, v80
    v_mfma_f32_16x16x32_bf16 v[52:55], v[200:203], v[132:135], v[52:55]
    ds_read_b64_tr_b16 v[186:187], v234 offset:28672
    v_max3_f32 v240, v240, v81, v82
    v_mfma_f32_16x16x32_bf16 v[60:63], v[204:207], v[132:135], v[60:63]
    ds_read_b64_tr_b16 v[188:189], v235 offset:24576
    v_max3_f32 v240, v240, v83, v84
    v_max3_f32 v240, v240, v85, v86
    v_mfma_f32_16x16x32_bf16 v[56:59], v[204:207], v[128:131], v[56:59]
    ds_read_b64_tr_b16 v[190:191], v235 offset:28672
    v_max3_f32 v240, v240, v87, v88
    v_mfma_f32_16x16x32_bf16 v[208:211], v[224:227], v[128:131], v[208:211]
    v_max3_f32 v240, v240, v89, v90
    s_waitcnt lgkmcnt(4)
    v_mfma_f32_16x16x32_bf16 v[212:215], v[224:227], v[132:135], v[212:215]
    v_max3_f32 v240, v240, v91, v92
    v_max3_f32 v240, v240, v93, v94
    v_max_f32 v240, v240, v95
    v_cmp_lt_f32 vcc, s65, v240
    s_mov_b32 s80, 0
    s_cbranch_vccnz L_rescale0
L_ret0_0:
    v_mfma_f32_16x16x32_bf16 v[0:3], v[176:179], v[136:139], v[0:3]
    ds_read_b64_tr_b16 v[192:193], v236 offset:24576
    ds_read_b64_tr_b16 v[194:195], v236 offset:28672
    v_mfma_f32_16x16x32_bf16 v[4:7], v[176:179], v[140:143], v[4:7]
    v_exp_f32 v64, v64
    v_mfma_f32_16x16x32_bf16 v[12:15], v[180:183], v[140:143], v[12:15]
    ds_read_b64_tr_b16 v[196:197], v237 offset:24576
    v_exp_f32 v65, v65
    v_mfma_f32_16x16x32_bf16 v[8:11], v[180:183], v[136:139], v[8:11]
    ds_read_b64_tr_b16 v[198:199], v237 offset:28672
    s_waitcnt lgkmcnt(4)
    v_mfma_f32_16x16x32_bf16 v[16:19], v[184:187], v[136:139], v[16:19]
    ds_read_b64_tr_b16 v[200:201], v238 offset:24576
    ds_read_b64_tr_b16 v[202:203], v238 offset:28672
    v_mfma_f32_16x16x32_bf16 v[20:23], v[184:187], v[140:143], v[20:23]
    v_exp_f32 v66, v66
    v_mfma_f32_16x16x32_bf16 v[28:31], v[188:191], v[140:143], v[28:31]
    ds_read_b64_tr_b16 v[204:205], v239 offset:24576
    v_cvt_pk_bf16_f32 v128, v64, v65
    v_mfma_f32_16x16x32_bf16 v[24:27], v[188:191], v[136:139], v[24:27]
    ds_read_b64_tr_b16 v[206:207], v239 offset:28672
    s_waitcnt lgkmcnt(4)
    v_mfma_f32_16x16x32_bf16 v[32:35], v[192:195], v[136:139], v[32:35]
    v_exp_f32 v67, v67
    v_exp_f32 v72, v72
    v_mfma_f32_16x16x32_bf16 v[36:39], v[192:195], v[140:143], v[36:39]
    v_exp_f32 v73, v73
    v_mfma_f32_16x16x32_bf16 v[44:47], v[196:199], v[140:143], v[44:47]
    v_cvt_pk_bf16_f32 v129, v66, v67
    s_waitcnt lgkmcnt(0)
    v_mfma_f32_16x16x32_bf16 v[40:43], v[196:199], v[136:139], v[40:43]
    v_exp_f32 v74, v74
    v_cvt_pk_bf16_f32 v130, v72, v73
    v_mfma_f32_16x16x32_bf16 v[48:51], v[200:203], v[136:139], v[48:51]
    v_exp_f32 v75, v75
    v_mfma_f32_16x16x32_bf16 v[52:55], v[200:203], v[140:143], v[52:55]
    v_exp_f32 v68, v68
    v_cvt_pk_bf16_f32 v131, v74, v75
    v_mfma_f32_16x16x32_bf16 v[60:63], v[204:207], v[140:143], v[60:63]
    v_exp_f32 v69, v69
    v_exp_f32 v70, v70
    v_mfma_f32_16x16x32_bf16 v[56:59], v[204:207], v[136:139], v[56:59]
    v_exp_f32 v71, v71
    v_mfma_f32_16x16x32_bf16 v[208:211], v[224:227], v[136:139], v[208:211]
    v_exp_f32 v76, v76
    v_cvt_pk_bf16_f32 v132, v68, v69
    v_mfma_f32_16x16x32_bf16 v[212:215], v[224:227], v[140:143], v[212:215]
    v_exp_f32 v77, v77
    v_cvt_pk_bf16_f32 v133, v70, v71
    v_cvt_pk_bf16_f32 v134, v76, v77
    s_sub_u32 s66, s66, 1
    s_cmp_eq_u32 s66, 0
    s_cbranch_scc1 L_last
    s_barrier
    ds_read_b128 v[176:179], v228 offset:49152
    ds_read_b128 v[180:183], v228 offset:53248
    ds_read_b128 v[184:187], v228 offset:57344
    ds_read_b128 v[188:191], v228 offset:61440
    v_exp_f32 v78, v78
    v_exp_f32 v79, v79
    s_waitcnt lgkmcnt(2)
    v_mfma_f32_16x16x32_bf16 v[96:99], v[176:179], v[144:147], v[216:219]
    ds_read_b128 v[192:195], v229 offset:49152
    v_mfma_f32_16x16x32_bf16 v[100:103], v[176:179], v[148:151], v[220:223]
    v_mfma_f32_16x16x32_bf16 v[108:111], v[180:183], v[148:151], v[220:223]
    ds_read_b128 v[196:199], v229 offset:53248
    s_waitcnt lgkmcnt(2)
    v_mfma_f32_16x16x32_bf16 v[104:107], v[180:183], v[144:147], v[216:219]
    v_mfma_f32_16x16x32_bf16 v[112:115], v[184:187], v[144:147], v[216:219]
    ds_read_b128 v[200:203], v229 offset:57344
    v_mfma_f32_16x16x32_bf16 v[116:119], v[184:187], v[148:151], v[220:223]
    v_exp_f32 v80, v80
    v_mfma_f32_16x16x32_bf16 v[124:127], v[188:191], v[148:151], v[220:223]
    ds_read_b128 v[204:207], v229 offset:61440
    s_waitcnt lgkmcnt(2)
    v_mfma_f32_16x16x32_bf16 v[120:123], v[188:191], v[144:147], v[216:219]
    v_exp_f32 v81, v81
    v_cvt_pk_bf16_f32 v135, v78, v79
    v_mfma_f32_16x16x32_bf16 v[96:99], v[192:195], v[152:155], v[96:99]
    ds_read_b128 v[176:179], v230 offset:49152
    v_cvt_pk_bf16_f32 v136, v80, v81
    v_mfma_f32_16x16x32_bf16 v[100:103], v[192:195], v[156:159], v[100:103]
    v_exp_f32 v82, v82
    v_exp_f32 v83, v83
    v_mfma_f32_16x16x32_bf16 v[108:111], v[196:199], v[156:159], v[108:111]
    ds_read_b128 v[180:183], v230 offset:53248
    s_waitcnt lgkmcnt(2)
    v_mfma_f32_16x16x32_bf16 v[104:107], v[196:199], v[152:155], v[104:107]
    v_exp_f32 v88, v88
    v_mfma_f32_16x16x32_bf16 v[112:115], v[200:203], v[152:155], v[112:115]
    ds_read_b128 v[184:187], v230 offset:57344
    v_cvt_pk_bf16_f32 v137, v82, v83
    v_mfma_f32_16x16x32_bf16 v[116:119], v[200:203], v[156:159], v[116:119]
    v_exp_f32 v89, v89
    v_exp_f32 v90, v90
    v_mfma_f32_16x16x32_bf16 v[124:127], v[204:207], v[156:159], v[124:127]
    ds_read_b128 v[188:191], v230 offset:61440
    s_waitcnt lgkmcnt(2)
    v_mfma_f32_16x16x32_bf16 v[120:123], v[204:207], v[152:155], v[120:123]
    v_exp_f32 v91, v91
    v_mfma_f32_16x16x32_bf16 v[96:99], v[176:179], v[160:163], v[96:99]
    ds_read_b128 v[192:195], v231 offset:49152
    v_cvt_pk_bf16_f32 v138, v88, v89
    v_mfma_f32_16x16x32_bf16 v[100:103], v[176:179], v[164:167], v[100:103]
    v_exp_f32 v84, v84
    v_mfma_f32_16x16x32_bf16 v[108:111], v[180:183], v[164:167], v[108:111]
    ds_read_b128 v[196:199], v231 offset:53248
    s_waitcnt lgkmcnt(2)
    v_mfma_f32_16x16x32_bf16 v[104:107], v[180:183], v[160:163], v[104:107]
    v_exp_f32 v85, v85
    v_cvt_pk_bf16_f32 v139, v90, v91
    v_mfma_f32_16x16x32_bf16 v[112:115], v[184:187], v[160:163], v[112:115]
    ds_read_b128 v[200:203], v231 offset:57344
    v_cvt_pk_bf16_f32 v140, v84, v85
    v_mfma_f32_16x16x32_bf16 v[116:119], v[184:187], v[164:167], v[116:119]
    v_exp_f32 v86, v86
    v_exp_f32 v87, v87
    v_mfma_f32_16x16x32_bf16 v[124:127], v[188:191], v[164:167], v[124:127]
    ds_read_b128 v[204:207], v231 offset:61440
    s_waitcnt lgkmcnt(2)
    v_mfma_f32_16x16x32_bf16 v[120:123], v[188:191], v[160:163], v[120:123]
    v_exp_f32 v92, v92
    v_mfma_f32_16x16x32_bf16 v[96:99], v[192:195], v[168:171], v[96:99]
    ds_read_b64_tr_b16 v[176:177], v232 offset:32768
    ds_read_b64_tr_b16 v[178:179], v232 offset:36864
    v_mfma_f32_16x16x32_bf16 v[100:103], v[192:195], v[172:175], v[100:103]
    v_exp_f32 v93, v93
    v_mfma_f32_16x16x32_bf16 v[108:111], v[196:199], v[172:175], v[108:111]
    ds_read_b64_tr_b16 v[180:181], v233 offset:32768
    v_cvt_pk_bf16_f32 v141, v86, v87
    v_cvt_pk_bf16_f32 v142, v92, v93
    v_mfma_f32_16x16x32_bf16 v[104:107], v[196:199], v[168:171], v[104:107]
    ds_read_b64_tr_b16 v[182:183], v233 offset:36864
    s_waitcnt lgkmcnt(4)
    v_mfma_f32_16x16x32_bf16 v[112:115], v[200:203], v[168:171], v[112:115]
    ds_read_b64_tr_b16 v[184:185], v234 offset:32768
    ds_read_b64_tr_b16 v[186:187], v234 offset:36864
    v_mfma_f32_16x16x32_bf16 v[116:119], v[200:203], v[172:175], v[116:119]
    v_exp_f32 v94, v94
    v_mfma_f32_16x16x32_bf16 v[124:127], v[204:207], v[172:175], v[124:127]
    ds_read_b64_tr_b16 v[188:189], v235 offset:32768
    v_exp_f32 v95, v95
    v_mfma_f32_16x16x32_bf16 v[120:123], v[204:207], v[168:171], v[120:123]
    ds_read_b64_tr_b16 v[190:191], v235 offset:36864
    v_cvt_pk_bf16_f32 v143, v94, v95
    s_waitcnt lgkmcnt(4)
    v_mfma_f32_16x16x32_bf16 v[0:3], v[176:179], v[128:131], v[0:3]
    ds_read_b64_tr_b16 v[192:193], v236 offset:32768
    v_mfma_f32_16x16x32_bf16 v[4:7], v[176:179], v[132:135], v[4:7]
    ds_read_b64_tr_b16 v[194:195], v236 offset:36864
    v_mfma_f32_16x16x32_bf16 v[12:15], v[180:183], v[132:135], v[12:15]
    ds_read_b64_tr_b16 v[196:197], v237 offset:32768
    v_max3_f32 v240, v96, v97, v98
    v_mfma_f32_16x16x32_bf16 v[8:11], v[180:183], v[128:131], v[8:11]
    ds_read_b64_tr_b16 v[198:199], v237 offset:36864
    s_waitcnt lgkmcnt(4)
    v_mfma_f32_16x16x32_bf16 v[16:19], v[184:187], v[128:131], v[16:19]
    ds_read_b64_tr_b16 v[200:201], v238 offset:32768
    v_max3_f32 v240, v240, v99, v100
    v_mfma_f32_16x16x32_bf16 v[20:23], v[184:187], v[132:135], v[20:23]
    ds_read_b64_tr_b16 v[202:203], v238 offset:36864
    v_max3_f32 v240, v240, v101, v102
    v_mfma_f32_16x16x32_bf16 v[28:31], v[188:191], v[132:135], v[28:31]
    ds_read_b64_tr_b16 v[204:205], v239 offset:32768
    v_max3_f32 v240, v240, v103, v104
    v_mfma_f32_16x16x32_bf16 v[24:27], v[188:191], v[128:131], v[24:27]
    ds_read_b64_tr_b16 v[206:207], v239 offset:36864
    s_waitcnt lgkmcnt(4)
    v_mfma_f32_16x16x32_bf16 v[32:35], v[192:195], v[128:131], v[32:35]
    ds_read_b64_tr_b16 v[176:177], v232 offset:40960
    v_max3_f32 v240, v240, v105, v106
    v_mfma_f32_16x16x32_bf16 v[36:39], v[192:195], v[132:135], v[36:39]
    ds_read_b64_tr_b16 v[178:179], v232 offset:45056
    v_max3_f32 v240, v240, v107, v108
    v_mfma_f32_16x16x32_bf16 v[44:47], v[196:199], v[132:135], v[44:47]
    ds_read_b64_tr_b16 v[180:181], v233 offset:40960
    v_max3_f32 v240, v240, v109, v110
    v_mfma_f32_16x16x32_bf16 v[40:43], v[196:199], v[128:131], v[40:43]
    ds_read_b64_tr_b16 v[182:183], v233 offset:45056
    s_waitcnt lgkmcnt(4)
    v_mfma_f32_16x16x32_bf16 v[48:51], v[200:203], v[128:131], v[48:51]
    ds_read_b64_tr_b16 v[184:185], v234 offset:40960
    v_max3_f32 v240, v240, v111, v112
    v_mfma_f32_16x16x32_bf16 v[52:55], v[200:203], v[132:135], v[52:55]
    ds_read_b64_tr_b16 v[186:187], v234 offset:45056
    v_max3_f32 v240, v240, v113, v114
    v_mfma_f32_16x16x32_bf16 v[60:63], v[204:207], v[132:135], v[60:63]
    ds_read_b64_tr_b16 v[188:189], v235 offset:40960
    v_max3_f32 v240, v240, v115, v116
    v_max3_f32 v240, v240, v117, v118
    v_mfma_f32_16x16x32_bf16 v[56:59], v[204:207], v[128:131], v[56:59]
    ds_read_b64_tr_b16 v[190:191], v235 offset:45056
    v_max3_f32 v240, v240, v119, v120
    v_mfma_f32_16x16x32_bf16 v[208:211], v[224:227], v[128:131], v[208:211]
    v_max3_f32 v240, v240, v121, v122
    s_waitcnt lgkmcnt(4)
    v_mfma_f32_16x16x32_bf16 v[212:215], v[224:227], v[132:135], v[212:215]
    v_max3_f32 v240, v240, v123, v124
    v_max3_f32 v240, v240, v125, v126
    v_max_f32 v240, v240, v127
    v_cmp_lt_f32 vcc, s65, v240
    s_mov_b32 s80, 1
    s_cbranch_vccnz L_rescale1
L_ret1_1:
    v_mfma_f32_16x16x32_bf16 v[0:3], v[176:179], v[136:139], v[0:3]
    ds_read_b64_tr_b16 v[192:193], v236 offset:40960
    ds_read_b64_tr_b16 v[194:195], v236 offset:45056
    v_mfma_f32_16x16x32_bf16 v[4:7], v[176:179], v[140:143], v[4:7]
    v_exp_f32 v96, v96
    v_mfma_f32_16x16x32_bf16 v[12:15], v[180:183], v[140:143], v[12:15]
    ds_read_b64_tr_b16 v[196:197], v237 offset:40960
    v_exp_f32 v97, v97
    v_mfma_f32_16x16x32_bf16 v[8:11], v[180:183], v[136:139], v[8:11]
    ds_read_b64_tr_b16 v[198:199], v237 offset:45056
    s_waitcnt lgkmcnt(4)
    v_mfma_f32_16x16x32_bf16 v[16:19], v[184:187], v[136:139], v[16:19]
    ds_read_b64_tr_b16 v[200:201], v238 offset:40960
    ds_read_b64_tr_b16 v[202:203], v238 offset:45056
    v_mfma_f32_16x16x32_bf16 v[20:23], v[184:187], v[140:143], v[20:23]
    v_exp_f32 v98, v98
    v_mfma_f32_16x16x32_bf16 v[28:31], v[188:191], v[140:143], v[28:31]
    ds_read_b64_tr_b16 v[204:205], v239 offset:40960
    v_cvt_pk_bf16_f32 v128, v96, v97
    v_mfma_f32_16x16x32_bf16 v[24:27], v[188:191], v[136:139], v[24:27]
    ds_read_b64_tr_b16 v[206:207], v239 offset:45056
    s_waitcnt lgkmcnt(4)
    v_mfma_f32_16x16x32_bf16 v[32:35], v[192:195], v[136:139], v[32:35]
    v_exp_f32 v99, v99
    v_exp_f32 v104, v104
    v_mfma_f32_16x16x32_bf16 v[36:39], v[192:195], v[140:143], v[36:39]
    v_exp_f32 v105, v105
    v_mfma_f32_16x16x32_bf16 v[44:47], v[196:199], v[140:143], v[44:47]
    v_cvt_pk_bf16_f32 v129, v98, v99
    s_waitcnt lgkmcnt(0)
    v_mfma_f32_16x16x32_bf16 v[40:43], v[196:199], v[136:139], v[40:43]
    v_exp_f32 v106, v106
    v_cvt_pk_bf16_f32 v130, v104, v105
    v_mfma_f32_16x16x32_bf16 v[48:51], v[200:203], v[136:139], v[48:51]
    v_exp_f32 v107, v107
    v_mfma_f32_16x16x32_bf16 v[52:55], v[200:203], v[140:143], v[52:55]
    v_exp_f32 v100, v100
    v_cvt_pk_bf16_f32 v131, v106, v107
    v_mfma_f32_16x16x32_bf16 v[60:63], v[204:207], v[140:143], v[60:63]
    v_exp_f32 v101, v101
    v_exp_f32 v102, v102
    v_mfma_f32_16x16x32_bf16 v[56:59], v[204:207], v[136:139], v[56:59]
    v_exp_f32 v103, v103
    v_mfma_f32_16x16x32_bf16 v[208:211], v[224:227], v[136:139], v[208:211]
    v_exp_f32 v108, v108
    v_cvt_pk_bf16_f32 v132, v100, v101
    v_mfma_f32_16x16x32_bf16 v[212:215], v[224:227], v[140:143], v[212:215]
    v_exp_f32 v109, v109
    v_cvt_pk_bf16_f32 v133, v102, v103
    v_cvt_pk_bf16_f32 v134, v108, v109
    s_barrier
    ds_read_b128 v[176:179], v228 offset:0
    ds_read_b128 v[180:183], v228 offset:4096
    ds_read_b128 v[184:187], v228 offset:8192
    ds_read_b128 v[188:191], v228 offset:12288
    v_exp_f32 v110, v110
    v_exp_f32 v111, v111
    s_waitcnt lgkmcnt(2)
    v_mfma_f32_16x16x32_bf16 v[64:67], v[176:179], v[144:147], v[216:219]
    ds_read_b128 v[192:195], v229 offset:0
    v_mfma_f32_16x16x32_bf16 v[68:71], v[176:179], v[148:151], v[220:223]
    v_mfma_f32_16x16x32_bf16 v[76:79], v[180:183], v[148:151], v[220:223]
    ds_read_b128 v[196:199], v229 offset:4096
    s_waitcnt lgkmcnt(2)
    v_mfma_f32_16x16x32_bf16 v[72:75], v[180:183], v[144:147], v[216:219]
    v_mfma_f32_16x16x32_bf16 v[80:83], v[184:187], v[144:147], v[216:219]
    ds_read_b128 v[200:203], v229 offset:8192
    v_mfma_f32_16x16x32_bf16 v[84:87], v[184:187], v[148:151], v[220:223]
    v_exp_f32 v112, v112
    v_mfma_f32_16x16x32_bf16 v[92:95], v[188:191], v[148:151], v[220:223]
    ds_read_b128 v[204:207], v229 offset:12288
    s_waitcnt lgkmcnt(2)
    v_mfma_f32_16x16x32_bf16 v[88:91], v[188:191], v[144:147], v[216:219]
    v_exp_f32 v113, v113
    v_cvt_pk_bf16_f32 v135, v110, v111
    v_mfma_f32_16x16x32_bf16 v[64:67], v[192:195], v[152:155], v[64:67]
    ds_read_b128 v[176:179], v230 offset:0
    v_cvt_pk_bf16_f32 v136, v112, v113
    v_mfma_f32_16x16x32_bf16 v[68:71], v[192:195], v[156:159], v[68:71]
    v_exp_f32 v114, v114
    v_exp_f32 v115, v115
    v_mfma_f32_16x16x32_bf16 v[76:79], v[196:199], v[156:159], v[76:79]
    ds_read_b128 v[180:183], v230 offset:4096
    s_waitcnt lgkmcnt(2)
    v_mfma_f32_16x16x32_bf16 v[72:75], v[196:199], v[152:155], v[72:75]
    v_exp_f32 v120, v120
    v_mfma_f32_16x16x32_bf16 v[80:83], v[200:203], v[152:155], v[80:83]
    ds_read_b128 v[184:187], v230 offset:8192
    v_cvt_pk_bf16_f32 v137, v114, v115
    v_mfma_f32_16x16x32_bf16 v[84:87], v[200:203], v[156:159], v[84:87]
    v_exp_f32 v121, v121
    v_exp_f32 v122, v122
    v_mfma_f32_16x16x32_bf16 v[92:95], v[204:207], v[156:159], v[92:95]
    ds_read_b128 v[188:191], v230 offset:12288
    s_waitcnt lgkmcnt(2)
    v_mfma_f32_16x16x32_bf16 v[88:91], v[204:207], v[152:155], v[88:91]
    v_exp_f32 v123, v123
    v_mfma_f32_16x16x32_bf16 v[64:67], v[176:179], v[160:163], v[64:67]
    ds_read_b128 v[192:195], v231 offset:0
    v_cvt_pk_bf16_f32 v138, v120, v121
    v_mfma_f32_16x16x32_bf16 v[68:71], v[176:179], v[164:167], v[68:71]
    v_exp_f32 v116, v116
    v_mfma_f32_16x16x32_bf16 v[76:79], v[180:183], v[164:167], v[76:79]
    ds_read_b128 v[196:199], v231 offset:4096
    s_waitcnt lgkmcnt(2)
    v_mfma_f32_16x16x32_bf16 v[72:75], v[180:183], v[160:163], v[72:75]
    v_exp_f32 v117, v117
    v_cvt_pk_bf16_f32 v139, v122, v123
    v_mfma_f32_16x16x32_bf16 v[80:83], v[184:187], v[160:163], v[80:83]
    ds_read_b128 v[200:203], v231 offset:8192
    v_cvt_pk_bf16_f32 v140, v116, v117
    v_mfma_f32_16x16x32_bf16 v[84:87], v[184:187], v[164:167], v[84:87]
    v_exp_f32 v118, v118
    v_exp_f32 v119, v119
    v_mfma_f32_16x16x32_bf16 v[92:95], v[188:191], v[164:167], v[92:95]
    ds_read_b128 v[204:207], v231 offset:12288
    s_waitcnt lgkmcnt(2)
    v_mfma_f32_16x16x32_bf16 v[88:91], v[188:191], v[160:163], v[88:91]
    v_exp_f32 v124, v124
    v_mfma_f32_16x16x32_bf16 v[64:67], v[192:195], v[168:171], v[64:67]
    ds_read_b64_tr_b16 v[176:177], v232 offset:49152
    ds_read_b64_tr_b16 v[178:179], v232 offset:53248
    v_mfma_f32_16x16x32_bf16 v[68:71], v[192:195], v[172:175], v[68:71]
    v_exp_f32 v125, v125
    v_mfma_f32_16x16x32_bf16 v[76:79], v[196:199], v[172:175], v[76:79]
    ds_read_b64_tr_b16 v[180:181], v233 offset:49152
    v_cvt_pk_bf16_f32 v141, v118, v119
    v_cvt_pk_bf16_f32 v142, v124, v125
    v_mfma_f32_16x16x32_bf16 v[72:75], v[196:199], v[168:171], v[72:75]
    ds_read_b64_tr_b16 v[182:183], v233 offset:53248
    s_waitcnt lgkmcnt(4)
    v_mfma_f32_16x16x32_bf16 v[80:83], v[200:203], v[168:171], v[80:83]
    ds_read_b64_tr_b16 v[184:185], v234 offset:49152
    ds_read_b64_tr_b16 v[186:187], v234 offset:53248
    v_mfma_f32_16x16x32_bf16 v[84:87], v[200:203], v[172:175], v[84:87]
    v_exp_f32 v126, v126
    v_mfma_f32_16x16x32_bf16 v[92:95], v[204:207], v[172:175], v[92:95]
    ds_read_b64_tr_b16 v[188:189], v235 offset:49152
    v_exp_f32 v127, v127
    v_mfma_f32_16x16x32_bf16 v[88:91], v[204:207], v[168:171], v[88:91]
    ds_read_b64_tr_b16 v[190:191], v235 offset:53248
    v_cvt_pk_bf16_f32 v143, v126, v127
    s_waitcnt lgkmcnt(4)
    v_mfma_f32_16x16x32_bf16 v[0:3], v[176:179], v[128:131], v[0:3]
    ds_read_b64_tr_b16 v[192:193], v236 offset:49152
    v_mfma_f32_16x16x32_bf16 v[4:7], v[176:179], v[132:135], v[4:7]
    ds_read_b64_tr_b16 v[194:195], v236 offset:53248
    v_mfma_f32_16x16x32_bf16 v[12:15], v[180:183], v[132:135], v[12:15]
    ds_read_b64_tr_b16 v[196:197], v237 offset:49152
    v_max3_f32 v240, v64, v65, v66
    v_mfma_f32_16x16x32_bf16 v[8:11], v[180:183], v[128:131], v[8:11]
    ds_read_b64_tr_b16 v[198:199], v237 offset:53248
    s_waitcnt lgkmcnt(4)
    v_mfma_f32_16x16x32_bf16 v[16:19], v[184:187], v[128:131], v[16:19]
    ds_read_b64_tr_b16 v[200:201], v238 offset:49152
    v_max3_f32 v240, v240, v67, v68
    v_mfma_f32_16x16x32_bf16 v[20:23], v[184:187], v[132:135], v[20:23]
    ds_read_b64_tr_b16 v[202:203], v238 offset:53248
    v_max3_f32 v240, v240, v69, v70
    v_mfma_f32_16x16x32_bf16 v[28:31], v[188:191], v[132:135], v[28:31]
    ds_read_b64_tr_b16 v[204:205], v239 offset:49152
    v_max3_f32 v240, v240, v71, v72
    v_mfma_f32_16x16x32_bf16 v[24:27], v[188:191], v[128:131], v[24:27]
    ds_read_b64_tr_b16 v[206:207], v239 offset:53248
    s_waitcnt lgkmcnt(4)
    v_mfma_f32_16x16x32_bf16 v[32:35], v[192:195], v[128:131], v[32:35]
    ds_read_b64_tr_b16 v[176:177], v232 offset:57344
    v_max3_f32 v240, v240, v73, v74
    v_mfma_f32_16x16x32_bf16 v[36:39], v[192:195], v[132:135], v[36:39]
    ds_read_b64_tr_b16 v[178:179], v232 offset:61440
    v_max3_f32 v240, v240, v75, v76
    v_mfma_f32_16x16x32_bf16 v[44:47], v[196:199], v[132:135], v[44:47]
    ds_read_b64_tr_b16 v[180:181], v233 offset:57344
    v_max3_f32 v240, v240, v77, v78
    v_mfma_f32_16x16x32_bf16 v[40:43], v[196:199], v[128:131], v[40:43]
    ds_read_b64_tr_b16 v[182:183], v233 offset:61440
    s_waitcnt lgkmcnt(4)
    v_mfma_f32_16x16x32_bf16 v[48:51], v[200:203], v[128:131], v[48:51]
    ds_read_b64_tr_b16 v[184:185], v234 offset:57344
    v_max3_f32 v240, v240, v79, v80
    v_mfma_f32_16x16x32_bf16 v[52:55], v[200:203], v[132:135], v[52:55]
    ds_read_b64_tr_b16 v[186:187], v234 offset:61440
    v_max3_f32 v240, v240, v81, v82
    v_mfma_f32_16x16x32_bf16 v[60:63], v[204:207], v[132:135], v[60:63]
    ds_read_b64_tr_b16 v[188:189], v235 offset:57344
    v_max3_f32 v240, v240, v83, v84
    v_max3_f32 v240, v240, v85, v86
    v_mfma_f32_16x16x32_bf16 v[56:59], v[204:207], v[128:131], v[56:59]
    ds_read_b64_tr_b16 v[190:191], v235 offset:61440
    v_max3_f32 v240, v240, v87, v88
    v_mfma_f32_16x16x32_bf16 v[208:211], v[224:227], v[128:131], v[208:211]
    v_max3_f32 v240, v240, v89, v90
    s_waitcnt lgkmcnt(4)
    v_mfma_f32_16x16x32_bf16 v[212:215], v[224:227], v[132:135], v[212:215]
    v_max3_f32 v240, v240, v91, v92
    v_max3_f32 v240, v240, v93, v94
    v_max_f32 v240, v240, v95
    v_cmp_lt_f32 vcc, s65, v240
    s_mov_b32 s80, 1
    s_cbranch_vccnz L_rescale0
L_ret0_1:
    v_mfma_f32_16x16x32_bf16 v[0:3], v[176:179], v[136:139], v[0:3]
    ds_read_b64_tr_b16 v[192:193], v236 offset:57344
    ds_read_b64_tr_b16 v[194:195], v236 offset:61440
    v_mfma_f32_16x16x32_bf16 v[4:7], v[176:179], v[140:143], v[4:7]
    v_exp_f32 v64, v64
    v_mfma_f32_16x16x32_bf16 v[12:15], v[180:183], v[140:143], v[12:15]
    ds_read_b64_tr_b16 v[196:197], v237 offset:57344
    v_exp_f32 v65, v65
    v_mfma_f32_16x16x32_bf16 v[8:11], v[180:183], v[136:139], v[8:11]
    ds_read_b64_tr_b16 v[198:199], v237 offset:61440
    s_waitcnt lgkmcnt(4)
    v_mfma_f32_16x16x32_bf16 v[16:19], v[184:187], v[136:139], v[16:19]
    ds_read_b64_tr_b16 v[200:201], v238 offset:57344
    ds_read_b64_tr_b16 v[202:203], v238 offset:61440
    v_mfma_f32_16x16x32_bf16 v[20:23], v[184:187], v[140:143], v[20:23]
    v_exp_f32 v66, v66
    v_mfma_f32_16x16x32_bf16 v[28:31], v[188:191], v[140:143], v[28:31]
    ds_read_b64_tr_b16 v[204:205], v239 offset:57344
    v_cvt_pk_bf16_f32 v128, v64, v65
    v_mfma_f32_16x16x32_bf16 v[24:27], v[188:191], v[136:139], v[24:27]
    ds_read_b64_tr_b16 v[206:207], v239 offset:61440
    s_waitcnt lgkmcnt(4)
    v_mfma_f32_16x16x32_bf16 v[32:35], v[192:195], v[136:139], v[32:35]
    v_exp_f32 v67, v67
    v_exp_f32 v72, v72
    v_mfma_f32_16x16x32_bf16 v[36:39], v[192:195], v[140:143], v[36:39]
    v_exp_f32 v73, v73
    v_mfma_f32_16x16x32_bf16 v[44:47], v[196:199], v[140:143], v[44:47]
    v_cvt_pk_bf16_f32 v129, v66, v67
    s_waitcnt lgkmcnt(0)
    v_mfma_f32_16x16x32_bf16 v[40:43], v[196:199], v[136:139], v[40:43]
    v_exp_f32 v74, v74
    v_cvt_pk_bf16_f32 v130, v72, v73
    v_mfma_f32_16x16x32_bf16 v[48:51], v[200:203], v[136:139], v[48:51]
    v_exp_f32 v75, v75
    v_mfma_f32_16x16x32_bf16 v[52:55], v[200:203], v[140:143], v[52:55]
    v_exp_f32 v68, v68
    v_cvt_pk_bf16_f32 v131, v74, v75
    v_mfma_f32_16x16x32_bf16 v[60:63], v[204:207], v[140:143], v[60:63]
    v_exp_f32 v69, v69
    v_exp_f32 v70, v70
    v_mfma_f32_16x16x32_bf16 v[56:59], v[204:207], v[136:139], v[56:59]
    v_exp_f32 v71, v71
    v_mfma_f32_16x16x32_bf16 v[208:211], v[224:227], v[136:139], v[208:211]
    v_exp_f32 v76, v76
    v_cvt_pk_bf16_f32 v132, v68, v69
    v_mfma_f32_16x16x32_bf16 v[212:215], v[224:227], v[140:143], v[212:215]
    v_exp_f32 v77, v77
    v_cvt_pk_bf16_f32 v133, v70, v71
    v_cvt_pk_bf16_f32 v134, v76, v77
    s_branch L_loop
L_hello:
    s_cmp_eq_u32 s66, 2
    s_cbranch_scc1 L_hello_rd
    s_add_u32 s70, s7, 16
    v_mov_b32 v252, s70
    buffer_store_dword v252, v249, s[52:55], s5 offen
    s_branch L_hello_back
L_hello_rd:
    buffer_load_dword v252, v251, s[52:55], s4 offen sc1
    s_branch L_hello_back
L_last:
    s_waitcnt vmcnt(0)
    v_readfirstlane_b32 s75, v252
    s_nop 0
    s_and_b32 s76, s75, 15
    s_lshr_b32 s75, s75, 4
    s_cmp_eq_u32 s76, s9
    s_cselect_b32 s18, 1, 0
    s_cmp_eq_u32 s75, s6
    s_cselect_b32 s18, 0, s18
    s_barrier
    ds_read_b128 v[176:179], v228 offset:49152
    ds_read_b128 v[180:183], v228 offset:53248
    ds_read_b128 v[184:187], v228 offset:57344
    ds_read_b128 v[188:191], v228 offset:61440
    v_exp_f32 v78, v78
    v_exp_f32 v79, v79
    s_waitcnt lgkmcnt(2)
    v_mfma_f32_16x16x32_bf16 v[96:99], v[176:179], v[144:147], v[216:219]
    ds_read_b128 v[192:195], v229 offset:49152
    v_mfma_f32_16x16x32_bf16 v[100:103], v[176:179], v[148:151], v[220:223]
    v_mfma_f32_16x16x32_bf16 v[108:111], v[180:183], v[148:151], v[220:223]
    ds_read_b128 v[196:199], v229 offset:53248
    s_waitcnt lgkmcnt(2)
    v_mfma_f32_16x16x32_bf16 v[104:107], v[180:183], v[144:147], v[216:219]
    v_mfma_f32_16x16x32_bf16 v[112:115], v[184:187], v[144:147], v[216:219]
    ds_read_b128 v[200:203], v229 offset:57344
    v_mfma_f32_16x16x32_bf16 v[116:119], v[184:187], v[148:151], v[220:223]
    v_exp_f32 v80, v80
    v_mfma_f32_16x16x32_bf16 v[124:127], v[188:191], v[148:151], v[220:223]
    ds_read_b128 v[204:207], v229 offset:61440
    s_waitcnt lgkmcnt(2)
    v_mfma_f32_16x16x32_bf16 v[120:123], v[188:191], v[144:147], v[216:219]
    v_exp_f32 v81, v81
    v_cvt_pk_bf16_f32 v135, v78, v79
    v_mfma_f32_16x16x32_bf16 v[96:99], v[192:195], v[152:155], v[96:99]
    ds_read_b128 v[176:179], v230 offset:49152
    v_cvt_pk_bf16_f32 v136, v80, v81
    v_mfma_f32_16x16x32_bf16 v[100:103], v[192:195], v[156:159], v[100:103]
    v_exp_f32 v82, v82
    v_exp_f32 v83, v83
    v_mfma_f32_16x16x32_bf16 v[108:111], v[196:199], v[156:159], v[108:111]
    ds_read_b128 v[180:183], v230 offset:53248
    s_waitcnt lgkmcnt(2)
    v_mfma_f32_16x16x32_bf16 v[104:107], v[196:199], v[152:155], v[104:107]
    v_exp_f32 v88, v88
    v_mfma_f32_16x16x32_bf16 v[112:115], v[200:203], v[152:155], v[112:115]
    ds_read_b128 v[184:187], v230 offset:57344
    v_cvt_pk_bf16_f32 v137, v82, v83
    v_mfma_f32_16x16x32_bf16 v[116:119], v[200:203], v[156:159], v[116:119]
    v_exp_f32 v89, v89
    v_exp_f32 v90, v90
    v_mfma_f32_16x16x32_bf16 v[124:127], v[204:207], v[156:159], v[124:127]
    ds_read_b128 v[188:191], v230 offset:61440
    s_waitcnt lgkmcnt(2)
    v_mfma_f32_16x16x32_bf16 v[120:123], v[204:207], v[152:155], v[120:123]
    v_exp_f32 v91, v91
    v_mfma_f32_16x16x32_bf16 v[96:99], v[176:179], v[160:163], v[96:99]
    ds_read_b128 v[192:195], v231 offset:49152
    v_cvt_pk_bf16_f32 v138, v88, v89
    v_mfma_f32_16x16x32_bf16 v[100:103], v[176:179], v[164:167], v[100:103]
    v_exp_f32 v84, v84
    v_mfma_f32_16x16x32_bf16 v[108:111], v[180:183], v[164:167], v[108:111]
    ds_read_b128 v[196:199], v231 offset:53248
    s_waitcnt lgkmcnt(2)
    v_mfma_f32_16x16x32_bf16 v[104:107], v[180:183], v[160:163], v[104:107]
    v_exp_f32 v85, v85
    v_cvt_pk_bf16_f32 v139, v90, v91
    v_mfma_f32_16x16x32_bf16 v[112:115], v[184:187], v[160:163], v[112:115]
    ds_read_b128 v[200:203], v231 offset:57344
    v_cvt_pk_bf16_f32 v140, v84, v85
    v_mfma_f32_16x16x32_bf16 v[116:119], v[184:187], v[164:167], v[116:119]
    v_exp_f32 v86, v86
    v_exp_f32 v87, v87
    v_mfma_f32_16x16x32_bf16 v[124:127], v[188:191], v[164:167], v[124:127]
    ds_read_b128 v[204:207], v231 offset:61440
    s_waitcnt lgkmcnt(2)
    v_mfma_f32_16x16x32_bf16 v[120:123], v[188:191], v[160:163], v[120:123]
    v_exp_f32 v92, v92
    v_mfma_f32_16x16x32_bf16 v[96:99], v[192:195], v[168:171], v[96:99]
    s_barrier
    ds_read_b64_tr_b16 v[176:177], v244 offset:0
    ds_read_b64_tr_b16 v[178:179], v244 offset:2048
    v_mfma_f32_16x16x32_bf16 v[100:103], v[192:195], v[172:175], v[100:103]
    v_exp_f32 v93, v93
    v_mfma_f32_16x16x32_bf16 v[108:111], v[196:199], v[172:175], v[108:111]
    ds_read_b64_tr_b16 v[180:181], v244 offset:4096
    v_cvt_pk_bf16_f32 v141, v86, v87
    v_cvt_pk_bf16_f32 v142, v92, v93
    v_mfma_f32_16x16x32_bf16 v[104:107], v[196:199], v[168:171], v[104:107]
    ds_read_b64_tr_b16 v[182:183], v244 offset:6144
    s_waitcnt lgkmcnt(4)
    v_mfma_f32_16x16x32_bf16 v[112:115], v[200:203], v[168:171], v[112:115]
    ds_read_b64_tr_b16 v[184:185], v245 offset:0
    ds_read_b64_tr_b16 v[186:187], v245 offset:2048
    v_mfma_f32_16x16x32_bf16 v[116:119], v[200:203], v[172:175], v[116:119]
    v_exp_f32 v94, v94
    v_mfma_f32_16x16x32_bf16 v[124:127], v[204:207], v[172:175], v[124:127]
    ds_read_b64_tr_b16 v[188:189], v245 offset:4096
    v_exp_f32 v95, v95
    v_mfma_f32_16x16x32_bf16 v[120:123], v[204:207], v[168:171], v[120:123]
    ds_read_b64_tr_b16 v[190:191], v245 offset:6144
    v_cvt_pk_bf16_f32 v143, v94, v95
    v_max3_f32 v240, v96, v97, v98
    v_max3_f32 v240, v240, v99, v100
    v_max3_f32 v240, v240, v101, v102
    v_max3_f32 v240, v240, v103, v104
    v_max3_f32 v240, v240, v105, v106
    v_max3_f32 v240, v240, v107, v108
    v_max3_f32 v240, v240, v109, v110
    v_max3_f32 v240, v240, v111, v112
    v_max3_f32 v240, v240, v113, v114
    v_max3_f32 v240, v240, v115, v116
    v_max3_f32 v240, v240, v117, v118
    v_max3_f32 v240, v240, v119, v120
    v_max3_f32 v240, v240, v121, v122
    v_max3_f32 v240, v240, v123, v124
    v_max3_f32 v240, v240, v125, v126
    v_max_f32 v240, v240, v127
    v_cmp_lt_f32 vcc, s65, v240
    s_mov_b32 s80, 0
    s_cbranch_vccnz L_rescale2
L_ret2_0:
    v_mfma_f32_16x16x32_bf16 v[208:211], v[224:227], v[128:131], v[208:211]
    v_exp_f32 v96, v96
    v_exp_f32 v97, v97
    v_exp_f32 v98, v98
    v_cvt_pk_bf16_f32 v160, v96, v97
    v_mfma_f32_16x16x32_bf16 v[212:215], v[224:227], v[132:135], v[212:215]
    v_exp_f32 v99, v99
    v_exp_f32 v104, v104
    v_cvt_pk_bf16_f32 v161, v98, v99
    v_exp_f32 v105, v105
    v_exp_f32 v106, v106
    v_mfma_f32_16x16x32_bf16 v[208:211], v[224:227], v[136:139], v[208:211]
    v_cvt_pk_bf16_f32 v162, v104, v105
    v_exp_f32 v107, v107
    v_exp_f32 v100, v100
    s_waitcnt lgkmcnt(4)
    v_mfma_f32_16x16x32_bf16 v[212:215], v[224:227], v[140:143], v[212:215]
    v_exp_f32 v101, v101
    v_cvt_pk_bf16_f32 v163, v106, v107
    v_cvt_pk_bf16_f32 v164, v100, v101
    v_exp_f32 v102, v102
    v_exp_f32 v103, v103
    v_mfma_f32_16x16x32_bf16 v[32:35], v[176:179], v[128:131], v[32:35]
    ds_read_b64_tr_b16 v[192:193], v246 offset:0
    ds_read_b64_tr_b16 v[194:195], v246 offset:2048
    v_mfma_f32_16x16x32_bf16 v[36:39], v[176:179], v[132:135], v[36:39]
    v_exp_f32 v108, v108
    v_cvt_pk_bf16_f32 v165, v102, v103
    v_exp_f32 v109, v109
    v_exp_f32 v110, v110
    v_mfma_f32_16x16x32_bf16 v[36:39], v[180:183], v[140:143], v[36:39]
    ds_read_b64_tr_b16 v[196:197], v246 offset:4096
    v_cvt_pk_bf16_f32 v166, v108, v109
    v_exp_f32 v111, v111
    v_exp_f32 v112, v112
    v_mfma_f32_16x16x32_bf16 v[32:35], v[180:183], v[136:139], v[32:35]
    ds_read_b64_tr_b16 v[198:199], v246 offset:6144
    s_waitcnt lgkmcnt(4)
    v_mfma_f32_16x16x32_bf16 v[40:43], v[184:187], v[128:131], v[40:43]
    ds_read_b64_tr_b16 v[200:201], v247 offset:0
    ds_read_b64_tr_b16 v[202:203], v247 offset:2048
    v_mfma_f32_16x16x32_bf16 v[44:47], v[184:187], v[132:135], v[44:47]
    v_exp_f32 v113, v113
    v_cvt_pk_bf16_f32 v167, v110, v111
    v_cvt_pk_bf16_f32 v168, v112, v113
    v_exp_f32 v114, v114
    v_exp_f32 v115, v115
    v_mfma_f32_16x16x32_bf16 v[44:47], v[188:191], v[140:143], v[44:47]
    ds_read_b64_tr_b16 v[204:205], v247 offset:4096
    v_exp_f32 v120, v120
    v_cvt_pk_bf16_f32 v169, v114, v115
    v_exp_f32 v121, v121
    v_mfma_f32_16x16x32_bf16 v[40:43], v[188:191], v[136:139], v[40:43]
    ds_read_b64_tr_b16 v[206:207], v247 offset:6144
    s_waitcnt lgkmcnt(4)
    v_mfma_f32_16x16x32_bf16 v[48:51], v[192:195], v[128:131], v[48:51]
    s_barrier
    ds_read_b64_tr_b16 v[176:177], v244 offset:16384
    ds_read_b64_tr_b16 v[178:179], v244 offset:18432
    v_mfma_f32_16x16x32_bf16 v[52:55], v[192:195], v[132:135], v[52:55]
    v_exp_f32 v122, v122
    v_cvt_pk_bf16_f32 v170, v120, v121
    v_exp_f32 v123, v123
    v_exp_f32 v116, v116
    v_cvt_pk_bf16_f32 v171, v122, v123
    v_mfma_f32_16x16x32_bf16 v[52:55], v[196:199], v[140:143], v[52:55]
    ds_read_b64_tr_b16 v[180:181], v244 offset:20480
    v_exp_f32 v117, v117
    v_exp_f32 v118, v118
    v_mfma_f32_16x16x32_bf16 v[48:51], v[196:199], v[136:139], v[48:51]
    ds_read_b64_tr_b16 v[182:183], v244 offset:22528
    s_waitcnt lgkmcnt(4)
    v_mfma_f32_16x16x32_bf16 v[56:59], v[200:203], v[128:131], v[56:59]
    ds_read_b64_tr_b16 v[184:185], v245 offset:16384
    ds_read_b64_tr_b16 v[186:187], v245 offset:18432
    v_mfma_f32_16x16x32_bf16 v[60:63], v[200:203], v[132:135], v[60:63]
    v_exp_f32 v119, v119
    v_cvt_pk_bf16_f32 v172, v116, v117
    v_cvt_pk_bf16_f32 v173, v118, v119
    v_exp_f32 v124, v124
    v_exp_f32 v125, v125
    v_mfma_f32_16x16x32_bf16 v[60:63], v[204:207], v[140:143], v[60:63]
    ds_read_b64_tr_b16 v[188:189], v245 offset:20480
    v_exp_f32 v126, v126
    v_cvt_pk_bf16_f32 v174, v124, v125
    v_exp_f32 v127, v127
    v_mfma_f32_16x16x32_bf16 v[56:59], v[204:207], v[136:139], v[56:59]
    ds_read_b64_tr_b16 v[190:191], v245 offset:22528
    v_cvt_pk_bf16_f32 v175, v126, v127
    s_cmp_eq_u32 s18, 0
    s_cbranch_scc1 L_pub_far
    v_mfma_f32_16x16x32_bf16 v[208:211], v[224:227], v[160:163], v[208:211]
    v_mov_b32 v240, v216
    v_mov_b32 v241, v220
    v_mfma_f32_16x16x32_bf16 v[212:215], v[224:227], v[164:167], v[212:215]
    s_xor_b32 s77, s8, 128
    s_add_u32 s78, s77, 4096
    v_mfma_f32_16x16x32_bf16 v[208:211], v[224:227], v[168:171], v[208:211]
    s_mov_b32 s66, 1048576
    s_waitcnt lgkmcnt(4)
    v_mfma_f32_16x16x32_bf16 v[212:215], v[224:227], v[172:175], v[212:215]
    v_mfma_f32_16x16x32_bf16 v[32:35], v[176:179], v[160:163], v[32:35]
    ds_read_b64_tr_b16 v[192:193], v246 offset:16384
    v_mfma_f32_16x16x32_bf16 v[36:39], v[176:179], v[164:167], v[36:39]
    ds_read_b64_tr_b16 v[194:195], v246 offset:18432
    v_mfma_f32_16x16x32_bf16 v[36:39], v[180:183], v[172:175], v[36:39]
    ds_read_b64_tr_b16 v[196:197], v246 offset:20480
    v_mfma_f32_16x16x32_bf16 v[32:35], v[180:183], v[168:171], v[32:35]
    ds_read_b64_tr_b16 v[198:199], v246 offset:22528
    v_mov_b32 v242, v208
    v_mov_b32 v243, v212
    s_mov_b64 exec, 0xffff
    buffer_store_dwordx4 v[240:243], v254, s[52:55], s81 offen
    s_mov_b64 exec, -1
    s_waitcnt lgkmcnt(4)
    v_mfma_f32_16x16x32_bf16 v[40:43], v[184:187], v[160:163], v[40:43]
    ds_read_b64_tr_b16 v[200:201], v247 offset:16384
    v_mfma_f32_16x16x32_bf16 v[44:47], v[184:187], v[164:167], v[44:47]
    ds_read_b64_tr_b16 v[202:203], v247 offset:18432
    v_mfma_f32_16x16x32_bf16 v[44:47], v[188:191], v[172:175], v[44:47]
    ds_read_b64_tr_b16 v[204:205], v247 offset:20480
    v_mfma_f32_16x16x32_bf16 v[40:43], v[188:191], v[168:171], v[40:43]
    ds_read_b64_tr_b16 v[206:207], v247 offset:22528
    v_cvt_pk_bf16_f32 v64, v32, v33
    v_cvt_pk_bf16_f32 v65, v34, v35
    v_cvt_pk_bf16_f32 v66, v36, v37
    v_cvt_pk_bf16_f32 v67, v38, v39
    buffer_store_dwordx4 v[64:67], v253, s[48:51], s77 offen offset:0
    s_waitcnt lgkmcnt(4)
    v_mfma_f32_16x16x32_bf16 v[48:51], v[192:195], v[160:163], v[48:51]
    s_barrier
    ds_read_b64_tr_b16 v[176:177], v244 offset:8192
    v_mfma_f32_16x16x32_bf16 v[52:55], v[192:195], v[164:167], v[52:55]
    ds_read_b64_tr_b16 v[178:179], v244 offset:10240
    v_mfma_f32_16x16x32_bf16 v[52:55], v[196:199], v[172:175], v[52:55]
    ds_read_b64_tr_b16 v[180:181], v244 offset:12288
    v_mfma_f32_16x16x32_bf16 v[48:51], v[196:199], v[168:171], v[48:51]
    ds_read_b64_tr_b16 v[182:183], v244 offset:14336
    v_cvt_pk_bf16_f32 v68, v40, v41
    v_cvt_pk_bf16_f32 v69, v42, v43
    v_cvt_pk_bf16_f32 v70, v44, v45
    v_cvt_pk_bf16_f32 v71, v46, v47
    buffer_store_dwordx4 v[68:71], v253, s[48:51], s77 offen offset:2048
    s_waitcnt lgkmcnt(4)
    v_mfma_f32_16x16x32_bf16 v[56:59], v[200:203], v[160:163], v[56:59]
    ds_read_b64_tr_b16 v[184:185], v245 offset:8192
    v_mfma_f32_16x16x32_bf16 v[60:63], v[200:203], v[164:167], v[60:63]
    ds_read_b64_tr_b16 v[186:187], v245 offset:10240
    v_mfma_f32_16x16x32_bf16 v[60:63], v[204:207], v[172:175], v[60:63]
    ds_read_b64_tr_b16 v[188:189], v245 offset:12288
    v_mfma_f32_16x16x32_bf16 v[56:59], v[204:207], v[168:171], v[56:59]
    ds_read_b64_tr_b16 v[190:191], v245 offset:14336
    v_cvt_pk_bf16_f32 v72, v48, v49
    v_cvt_pk_bf16_f32 v73, v50, v51
    v_cvt_pk_bf16_f32 v74, v52, v53
    v_cvt_pk_bf16_f32 v75, v54, v55
    buffer_store_dwordx4 v[72:75], v253, s[48:51], s78 offen offset:0
    s_waitcnt lgkmcnt(4)
    v_mfma_f32_16x16x32_bf16 v[0:3], v[176:179], v[128:131], v[0:3]
    ds_read_b64_tr_b16 v[192:193], v246 offset:8192
    v_mfma_f32_16x16x32_bf16 v[4:7], v[176:179], v[132:135], v[4:7]
    ds_read_b64_tr_b16 v[194:195], v246 offset:10240
    v_mfma_f32_16x16x32_bf16 v[4:7], v[180:183], v[140:143], v[4:7]
    ds_read_b64_tr_b16 v[196:197], v246 offset:12288
    v_mfma_f32_16x16x32_bf16 v[0:3], v[180:183], v[136:139], v[0:3]
    ds_read_b64_tr_b16 v[198:199], v246 offset:14336
    v_cvt_pk_bf16_f32 v76, v56, v57
    v_cvt_pk_bf16_f32 v77, v58, v59
    v_cvt_pk_bf16_f32 v78, v60, v61
    v_cvt_pk_bf16_f32 v79, v62, v63
    buffer_store_dwordx4 v[76:79], v253, s[48:51], s78 offen offset:2048
    s_waitcnt lgkmcnt(4)
    v_mfma_f32_16x16x32_bf16 v[8:11], v[184:187], v[128:131], v[8:11]
    ds_read_b64_tr_b16 v[200:201], v247 offset:8192
    v_add_u32 v224, 32, s7
    v_mfma_f32_16x16x32_bf16 v[12:15], v[184:187], v[132:135], v[12:15]
    ds_read_b64_tr_b16 v[202:203], v247 offset:10240
    v_add_u32 v225, 64, s7
    v_mfma_f32_16x16x32_bf16 v[12:15], v[188:191], v[140:143], v[12:15]
    ds_read_b64_tr_b16 v[204:205], v247 offset:12288
    s_lshl_b32 s70, s60, 13
    v_mfma_f32_16x16x32_bf16 v[8:11], v[188:191], v[136:139], v[8:11]
    ds_read_b64_tr_b16 v[206:207], v247 offset:14336
    s_waitcnt lgkmcnt(4)
    v_mfma_f32_16x16x32_bf16 v[16:19], v[192:195], v[128:131], v[16:19]
    s_barrier
    ds_read_b64_tr_b16 v[176:177], v244 offset:24576
    v_mfma_f32_16x16x32_bf16 v[20:23], v[192:195], v[132:135], v[20:23]
    ds_read_b64_tr_b16 v[178:179], v244 offset:26624
    s_add_u32 s70, s70, 131072
    v_mfma_f32_16x16x32_bf16 v[20:23], v[196:199], v[140:143], v[20:23]
    ds_read_b64_tr_b16 v[180:181], v244 offset:28672
    v_and_b32 v149, 15, v250
    v_mfma_f32_16x16x32_bf16 v[16:19], v[196:199], v[136:139], v[16:19]
    ds_read_b64_tr_b16 v[182:183], v244 offset:30720
    s_waitcnt lgkmcnt(4)
    v_mfma_f32_16x16x32_bf16 v[24:27], v[200:203], v[128:131], v[24:27]
    ds_read_b64_tr_b16 v[184:185], v245 offset:24576
    v_lshlrev_b32 v149, 7, v149
    v_mfma_f32_16x16x32_bf16 v[28:31], v[200:203], v[132:135], v[28:31]
    ds_read_b64_tr_b16 v[186:187], v245 offset:26624
    v_bfe_u32 v150, v250, 4, 1
    v_mfma_f32_16x16x32_bf16 v[28:31], v[204:207], v[140:143], v[28:31]
    ds_read_b64_tr_b16 v[188:189], v245 offset:28672
    v_lshl_add_u32 v149, v150, 3, v149
    v_mfma_f32_16x16x32_bf16 v[24:27], v[204:207], v[136:139], v[24:27]
    ds_read_b64_tr_b16 v[190:191], v245 offset:30720
    v_add_u32 v149, s70, v149
    v_and_b32 v150, 7, v250
    s_waitcnt lgkmcnt(4)
    v_mfma_f32_16x16x32_bf16 v[0:3], v[176:179], v[160:163], v[0:3]
    ds_read_b64_tr_b16 v[192:193], v246 offset:24576
    v_lshrrev_b32 v151, 5, v250
    v_mfma_f32_16x16x32_bf16 v[4:7], v[176:179], v[164:167], v[4:7]
    ds_read_b64_tr_b16 v[194:195], v246 offset:26624
    v_xor_b32 v151, v151, v150
    s_waitcnt vmcnt(0)
    buffer_load_dword v252, v251, s[52:55], s4 offen sc1
    buffer_store_dword v224, v249, s[52:55], s5 offen
    v_mfma_f32_16x16x32_bf16 v[4:7], v[180:183], v[172:175], v[4:7]
    ds_read_b64_tr_b16 v[196:197], v246 offset:28672
    v_xor_b32 v152, 0, v151
    v_mfma_f32_16x16x32_bf16 v[0:3], v[180:183], v[168:171], v[0:3]
    ds_read_b64_tr_b16 v[198:199], v246 offset:30720
    s_waitcnt lgkmcnt(4)
    v_mfma_f32_16x16x32_bf16 v[8:11], v[184:187], v[160:163], v[8:11]
    ds_read_b64_tr_b16 v[200:201], v247 offset:24576
    v_lshl_add_u32 v144, v152, 4, v149
    v_mfma_f32_16x16x32_bf16 v[12:15], v[184:187], v[164:167], v[12:15]
    ds_read_b64_tr_b16 v[202:203], v247 offset:26624
    v_xor_b32 v152, 2, v151
    v_mfma_f32_16x16x32_bf16 v[12:15], v[188:191], v[172:175], v[12:15]
    ds_read_b64_tr_b16 v[204:205], v247 offset:28672
    v_lshl_add_u32 v145, v152, 4, v149
    v_mfma_f32_16x16x32_bf16 v[8:11], v[188:191], v[168:171], v[8:11]
    ds_read_b64_tr_b16 v[206:207], v247 offset:30720
    s_waitcnt lgkmcnt(4)
    v_mfma_f32_16x16x32_bf16 v[16:19], v[192:195], v[160:163], v[16:19]
    v_xor_b32 v152, 4, v151
    v_lshl_add_u32 v146, v152, 4, v149
    v_mfma_f32_16x16x32_bf16 v[20:23], v[192:195], v[164:167], v[20:23]
    v_xor_b32 v152, 6, v151
    v_lshl_add_u32 v147, v152, 4, v149
    v_mfma_f32_16x16x32_bf16 v[20:23], v[196:199], v[172:175], v[20:23]
    v_lshrrev_b32 v151, 3, v250
    s_waitcnt lgkmcnt(0)
    v_mfma_f32_16x16x32_bf16 v[16:19], v[196:199], v[168:171], v[16:19]
    v_xor_b32 v150, v150, v151
    v_lshlrev_b32 v151, 7, v151
    v_mfma_f32_16x16x32_bf16 v[24:27], v[200:203], v[160:163], v[24:27]
    v_lshl_add_u32 v148, v150, 4, v151
    v_add_u32 v148, s70, v148
    v_mfma_f32_16x16x32_bf16 v[28:31], v[200:203], v[164:167], v[28:31]
    s_mov_b32 s79, 0xffff0000
    v_mfma_f32_16x16x32_bf16 v[28:31], v[204:207], v[172:175], v[28:31]
    v_mfma_f32_16x16x32_bf16 v[24:27], v[204:207], v[168:171], v[24:27]
    s_waitcnt vmcnt(1)
L_poll:
    v_readfirstlane_b32 s75, v252
    s_nop 0
    s_lshr_b32 s75, s75, 4
    s_sub_u32 s75, s75, s6
    s_and_b32 s75, s75, 0xffffffe
    s_cbranch_scc1 L_poll_ok
    buffer_load_dword v252, v251, s[52:55], s4 offen sc1
    s_sub_u32 s66, s66, 1
    s_waitcnt vmcnt(0)
    s_cbranch_scc0 L_poll
L_poll_ok:
    s_mov_b32 s74, s69
    buffer_load_dwordx4 v[244:247], v254, s[52:55], s74 offen sc1
    s_add_u32 s72, s8, 4096
    buffer_load_dwordx4 v[32:35], v253, s[48:51], s8 offen offset:0 sc1
    buffer_load_dwordx4 v[36:39], v253, s[48:51], s8 offen offset:2048 sc1
    buffer_load_dwordx4 v[40:43], v253, s[48:51], s72 offen offset:0 sc1
    buffer_load_dwordx4 v[44:47], v253, s[48:51], s72 offen offset:2048 sc1
    s_waitcnt vmcnt(4)
    v_min_f32 v236, v240, v244
    v_sub_f32 v232, v236, v240
    v_sub_f32 v234, v236, v244
    v_exp_f32 v232, v232
    v_exp_f32 v234, v234
    v_min_f32 v237, v241, v245
    v_sub_f32 v233, v237, v241
    v_sub_f32 v235, v237, v245
    v_exp_f32 v233, v233
    v_exp_f32 v235, v235
    v_mul_f32 v236, v232, v242
    v_fmac_f32 v236, v234, v246
    v_mul_f32 v237, v233, v243
    v_fmac_f32 v237, v235, v247
    v_rcp_f32 v236, v236
    v_rcp_f32 v237, v237
    v_mul_f32 v232, v232, v236
    v_mul_f32 v234, v234, v236
    v_mul_f32 v233, v233, v237
    v_mul_f32 v235, v235, v237
    v_pk_mul_f32 v[0:1], v[0:1], v[232:233] op_sel_hi:[1,0]
    v_pk_mul_f32 v[2:3], v[2:3], v[232:233] op_sel_hi:[1,0]
    v_pk_mul_f32 v[8:9], v[8:9], v[232:233] op_sel_hi:[1,0]
    v_pk_mul_f32 v[10:11], v[10:11], v[232:233] op_sel_hi:[1,0]
    v_pk_mul_f32 v[16:17], v[16:17], v[232:233] op_sel_hi:[1,0]
    v_pk_mul_f32 v[18:19], v[18:19], v[232:233] op_sel_hi:[1,0]
    v_pk_mul_f32 v[24:25], v[24:25], v[232:233] op_sel_hi:[1,0]
    v_pk_mul_f32 v[26:27], v[26:27], v[232:233] op_sel_hi:[1,0]
    v_pk_mul_f32 v[4:5], v[4:5], v[232:233] op_sel:[0,1]
    v_pk_mul_f32 v[6:7], v[6:7], v[232:233] op_sel:[0,1]
    v_pk_mul_f32 v[12:13], v[12:13], v[232:233] op_sel:[0,1]
    v_pk_mul_f32 v[14:15], v[14:15], v[232:233] op_sel:[0,1]
    v_pk_mul_f32 v[20:21], v[20:21], v[232:233] op_sel:[0,1]
    v_pk_mul_f32 v[22:23], v[22:23], v[232:233] op_sel:[0,1]
    v_pk_mul_f32 v[28:29], v[28:29], v[232:233] op_sel:[0,1]
    v_pk_mul_f32 v[30:31], v[30:31], v[232:233] op_sel:[0,1]
    s_waitcnt vmcnt(0)
    v_lshlrev_b32 v128, 16, v32
    v_and_b32 v129, s79, v32
    v_lshlrev_b32 v130, 16, v33
    v_and_b32 v131, s79, v33
    v_pk_fma_f32 v[0:1], v[128:129], v[234:235], v[0:1] op_sel_hi:[1,0,1]
    v_pk_fma_f32 v[2:3], v[130:131], v[234:235], v[2:3] op_sel_hi:[1,0,1]
    v_cvt_pk_bf16_f32 v96, v0, v1
    v_cvt_pk_bf16_f32 v97, v2, v3
    ds_write_b64 v144, v[96:97] offset:0
    v_lshlrev_b32 v128, 16, v36
    v_and_b32 v129, s79, v36
    v_lshlrev_b32 v130, 16, v37
    v_and_b32 v131, s79, v37
    v_pk_fma_f32 v[8:9], v[128:129], v[234:235], v[8:9] op_sel_hi:[1,0,1]
    v_pk_fma_f32 v[10:11], v[130:131], v[234:235], v[10:11] op_sel_hi:[1,0,1]
    v_cvt_pk_bf16_f32 v98, v8, v9
    v_cvt_pk_bf16_f32 v99, v10, v11
    ds_write_b64 v145, v[98:99] offset:0
    v_lshlrev_b32 v128, 16, v40
    v_and_b32 v129, s79, v40
    v_lshlrev_b32 v130, 16, v41
    v_and_b32 v131, s79, v41
    v_pk_fma_f32 v[16:17], v[128:129], v[234:235], v[16:17] op_sel_hi:[1,0,1]
    v_pk_fma_f32 v[18:19], v[130:131], v[234:235], v[18:19] op_sel_hi:[1,0,1]
    v_cvt_pk_bf16_f32 v100, v16, v17
    v_cvt_pk_bf16_f32 v101, v18, v19
    ds_write_b64 v146, v[100:101] offset:0
    v_lshlrev_b32 v128, 16, v44
    v_and_b32 v129, s79, v44
    v_lshlrev_b32 v130, 16, v45
    v_and_b32 v131, s79, v45
    v_pk_fma_f32 v[24:25], v[128:129], v[234:235], v[24:25] op_sel_hi:[1,0,1]
    v_pk_fma_f32 v[26:27], v[130:131], v[234:235], v[26:27] op_sel_hi:[1,0,1]
    v_cvt_pk_bf16_f32 v102, v24, v25
    v_cvt_pk_bf16_f32 v103, v26, v27
    ds_write_b64 v147, v[102:103] offset:0
    ds_read_b128 v[64:67], v148 offset:0
    ds_read_b128 v[68:71], v148 offset:1024
    v_lshlrev_b32 v128, 16, v34
    v_and_b32 v129, s79, v34
    v_lshlrev_b32 v130, 16, v35
    v_and_b32 v131, s79, v35
    v_pk_fma_f32 v[4:5], v[128:129], v[234:235], v[4:5] op_sel:[0,1,0]
    v_pk_fma_f32 v[6:7], v[130:131], v[234:235], v[6:7] op_sel:[0,1,0]
    v_cvt_pk_bf16_f32 v104, v4, v5
    v_cvt_pk_bf16_f32 v105, v6, v7
    ds_write_b64 v144, v[104:105] offset:2048
    v_lshlrev_b32 v128, 16, v38
    v_and_b32 v129, s79, v38
    v_lshlrev_b32 v130, 16, v39
    v_and_b32 v131, s79, v39
    v_pk_fma_f32 v[12:13], v[128:129], v[234:235], v[12:13] op_sel:[0,1,0]
    v_pk_fma_f32 v[14:15], v[130:131], v[234:235], v[14:15] op_sel:[0,1,0]
    v_cvt_pk_bf16_f32 v106, v12, v13
    v_cvt_pk_bf16_f32 v107, v14, v15
    ds_write_b64 v145, v[106:107] offset:2048
    s_waitcnt lgkmcnt(3)
    buffer_store_dwordx4 v[64:67], v253, s[48:51], s8 offen offset:0
    s_waitcnt lgkmcnt(2)
    buffer_store_dwordx4 v[68:71], v253, s[48:51], s8 offen offset:2048
    v_lshlrev_b32 v128, 16, v42
    v_and_b32 v129, s79, v42
    v_lshlrev_b32 v130, 16, v43
    v_and_b32 v131, s79, v43
    v_pk_fma_f32 v[20:21], v[128:129], v[234:235], v[20:21] op_sel:[0,1,0]
    v_pk_fma_f32 v[22:23], v[130:131], v[234:235], v[22:23] op_sel:[0,1,0]
    v_cvt_pk_bf16_f32 v108, v20, v21
    v_cvt_pk_bf16_f32 v109, v22, v23
    ds_write_b64 v146, v[108:109] offset:2048
    v_lshlrev_b32 v128, 16, v46
    v_and_b32 v129, s79, v46
    v_lshlrev_b32 v130, 16, v47
    v_and_b32 v131, s79, v47
    v_pk_fma_f32 v[28:29], v[128:129], v[234:235], v[28:29] op_sel:[0,1,0]
    v_pk_fma_f32 v[30:31], v[130:131], v[234:235], v[30:31] op_sel:[0,1,0]
    v_cvt_pk_bf16_f32 v110, v28, v29
    v_cvt_pk_bf16_f32 v111, v30, v31
    ds_write_b64 v147, v[110:111] offset:2048
    ds_read_b128 v[72:75], v148 offset:2048
    ds_read_b128 v[76:79], v148 offset:3072
    s_waitcnt lgkmcnt(1)
    buffer_store_dwordx4 v[72:75], v253, s[48:51], s72 offen offset:0
    s_waitcnt lgkmcnt(0)
    buffer_store_dwordx4 v[76:79], v253, s[48:51], s72 offen offset:2048
    s_cmp_eq_u32 s18, 0
    s_cbranch_scc1 L_ack_far
    buffer_store_dword v225, v249, s[52:55], s5 offen
L_ack_done:
L_end:
    s_endpgm
L_pub_far:
    s_waitcnt lgkmcnt(0)
    v_mfma_f32_16x16x32_bf16 v[208:211], v[224:227], v[160:163], v[208:211]
    v_mov_b32 v240, v216
    v_mov_b32 v241, v220
    v_mfma_f32_16x16x32_bf16 v[212:215], v[224:227], v[164:167], v[212:215]
    s_xor_b32 s77, s8, 128
    s_add_u32 s78, s77, 4096
    v_mfma_f32_16x16x32_bf16 v[208:211], v[224:227], v[168:171], v[208:211]
    s_mov_b32 s66, 1048576
    v_mfma_f32_16x16x32_bf16 v[212:215], v[224:227], v[172:175], v[212:215]
    v_mfma_f32_16x16x32_bf16 v[32:35], v[176:179], v[160:163], v[32:35]
    ds_read_b64_tr_b16 v[192:193], v246 offset:16384
    v_mfma_f32_16x16x32_bf16 v[36:39], v[176:179], v[164:167], v[36:39]
    ds_read_b64_tr_b16 v[194:195], v246 offset:18432
    v_mfma_f32_16x16x32_bf16 v[36:39], v[180:183], v[172:175], v[36:39]
    ds_read_b64_tr_b16 v[196:197], v246 offset:20480
    v_mfma_f32_16x16x32_bf16 v[32:35], v[180:183], v[168:171], v[32:35]
    ds_read_b64_tr_b16 v[198:199], v246 offset:22528
    v_mov_b32 v242, v208
    v_mov_b32 v243, v212
    s_mov_b64 exec, 0xffff
    buffer_store_dwordx4 v[240:243], v254, s[52:55], s81 offen sc1
    s_mov_b64 exec, -1
    v_mfma_f32_16x16x32_bf16 v[40:43], v[184:187], v[160:163], v[40:43]
    ds_read_b64_tr_b16 v[200:201], v247 offset:16384
    v_mfma_f32_16x16x32_bf16 v[44:47], v[184:187], v[164:167], v[44:47]
    ds_read_b64_tr_b16 v[202:203], v247 offset:18432
    v_mfma_f32_16x16x32_bf16 v[44:47], v[188:191], v[172:175], v[44:47]
    ds_read_b64_tr_b16 v[204:205], v247 offset:20480
    v_mfma_f32_16x16x32_bf16 v[40:43], v[188:191], v[168:171], v[40:43]
    ds_read_b64_tr_b16 v[206:207], v247 offset:22528
    v_cvt_pk_bf16_f32 v64, v32, v33
    v_cvt_pk_bf16_f32 v65, v34, v35
    v_cvt_pk_bf16_f32 v66, v36, v37
    v_cvt_pk_bf16_f32 v67, v38, v39
    buffer_store_dwordx4 v[64:67], v253, s[48:51], s77 offen offset:0 sc1
    s_waitcnt lgkmcnt(4)
    v_mfma_f32_16x16x32_bf16 v[48:51], v[192:195], v[160:163], v[48:51]
    s_barrier
    ds_read_b64_tr_b16 v[176:177], v244 offset:8192
    v_mfma_f32_16x16x32_bf16 v[52:55], v[192:195], v[164:167], v[52:55]
    ds_read_b64_tr_b16 v[178:179], v244 offset:10240
    v_mfma_f32_16x16x32_bf16 v[52:55], v[196:199], v[172:175], v[52:55]
    ds_read_b64_tr_b16 v[180:181], v244 offset:12288
    v_mfma_f32_16x16x32_bf16 v[48:51], v[196:199], v[168:171], v[48:51]
    ds_read_b64_tr_b16 v[182:183], v244 offset:14336
    v_cvt_pk_bf16_f32 v68, v40, v41
    v_cvt_pk_bf16_f32 v69, v42, v43
    v_cvt_pk_bf16_f32 v70, v44, v45
    v_cvt_pk_bf16_f32 v71, v46, v47
    buffer_store_dwordx4 v[68:71], v253, s[48:51], s77 offen offset:2048 sc1
    s_waitcnt lgkmcnt(4)
    v_mfma_f32_16x16x32_bf16 v[56:59], v[200:203], v[160:163], v[56:59]
    ds_read_b64_tr_b16 v[184:185], v245 offset:8192
    v_mfma_f32_16x16x32_bf16 v[60:63], v[200:203], v[164:167], v[60:63]
    ds_read_b64_tr_b16 v[186:187], v245 offset:10240
    v_mfma_f32_16x16x32_bf16 v[60:63], v[204:207], v[172:175], v[60:63]
    ds_read_b64_tr_b16 v[188:189], v245 offset:12288
    v_mfma_f32_16x16x32_bf16 v[56:59], v[204:207], v[168:171], v[56:59]
    ds_read_b64_tr_b16 v[190:191], v245 offset:14336
    v_cvt_pk_bf16_f32 v72, v48, v49
    v_cvt_pk_bf16_f32 v73, v50, v51
    v_cvt_pk_bf16_f32 v74, v52, v53
    v_cvt_pk_bf16_f32 v75, v54, v55
    buffer_store_dwordx4 v[72:75], v253, s[48:51], s78 offen offset:0 sc1
    s_waitcnt lgkmcnt(4)
    v_mfma_f32_16x16x32_bf16 v[0:3], v[176:179], v[128:131], v[0:3]
    ds_read_b64_tr_b16 v[192:193], v246 offset:8192
    v_mfma_f32_16x16x32_bf16 v[4:7], v[176:179], v[132:135], v[4:7]
    ds_read_b64_tr_b16 v[194:195], v246 offset:10240
    v_mfma_f32_16x16x32_bf16 v[4:7], v[180:183], v[140:143], v[4:7]
    ds_read_b64_tr_b16 v[196:197], v246 offset:12288
    v_mfma_f32_16x16x32_bf16 v[0:3], v[180:183], v[136:139], v[0:3]
    ds_read_b64_tr_b16 v[198:199], v246 offset:14336
    v_cvt_pk_bf16_f32 v76, v56, v57
    v_cvt_pk_bf16_f32 v77, v58, v59
    v_cvt_pk_bf16_f32 v78, v60, v61
    v_cvt_pk_bf16_f32 v79, v62, v63
    buffer_store_dwordx4 v[76:79], v253, s[48:51], s78 offen offset:2048 sc1
    s_waitcnt lgkmcnt(4)
    v_mfma_f32_16x16x32_bf16 v[8:11], v[184:187], v[128:131], v[8:11]
    ds_read_b64_tr_b16 v[200:201], v247 offset:8192
    v_add_u32 v224, 32, s7
    v_mfma_f32_16x16x32_bf16 v[12:15], v[184:187], v[132:135], v[12:15]
    ds_read_b64_tr_b16 v[202:203], v247 offset:10240
    v_add_u32 v225, 64, s7
    v_mfma_f32_16x16x32_bf16 v[12:15], v[188:191], v[140:143], v[12:15]
    ds_read_b64_tr_b16 v[204:205], v247 offset:12288
    s_lshl_b32 s70, s60, 13
    v_mfma_f32_16x16x32_bf16 v[8:11], v[188:191], v[136:139], v[8:11]
    ds_read_b64_tr_b16 v[206:207], v247 offset:14336
    s_waitcnt lgkmcnt(4)
    v_mfma_f32_16x16x32_bf16 v[16:19], v[192:195], v[128:131], v[16:19]
    s_barrier
    ds_read_b64_tr_b16 v[176:177], v244 offset:24576
    v_mfma_f32_16x16x32_bf16 v[20:23], v[192:195], v[132:135], v[20:23]
    ds_read_b64_tr_b16 v[178:179], v244 offset:26624
    s_add_u32 s70, s70, 131072
    v_mfma_f32_16x16x32_bf16 v[20:23], v[196:199], v[140:143], v[20:23]
    ds_read_b64_tr_b16 v[180:181], v244 offset:28672
    v_and_b32 v149, 15, v250
    v_mfma_f32_16x16x32_bf16 v[16:19], v[196:199], v[136:139], v[16:19]
    ds_read_b64_tr_b16 v[182:183], v244 offset:30720
    s_waitcnt lgkmcnt(4)
    v_mfma_f32_16x16x32_bf16 v[24:27], v[200:203], v[128:131], v[24:27]
    ds_read_b64_tr_b16 v[184:185], v245 offset:24576
    v_lshlrev_b32 v149, 7, v149
    v_mfma_f32_16x16x32_bf16 v[28:31], v[200:203], v[132:135], v[28:31]
    ds_read_b64_tr_b16 v[186:187], v245 offset:26624
    v_bfe_u32 v150, v250, 4, 1
    v_mfma_f32_16x16x32_bf16 v[28:31], v[204:207], v[140:143], v[28:31]
    ds_read_b64_tr_b16 v[188:189], v245 offset:28672
    v_lshl_add_u32 v149, v150, 3, v149
    v_mfma_f32_16x16x32_bf16 v[24:27], v[204:207], v[136:139], v[24:27]
    ds_read_b64_tr_b16 v[190:191], v245 offset:30720
    v_add_u32 v149, s70, v149
    v_and_b32 v150, 7, v250
    s_waitcnt lgkmcnt(4)
    v_mfma_f32_16x16x32_bf16 v[0:3], v[176:179], v[160:163], v[0:3]
    ds_read_b64_tr_b16 v[192:193], v246 offset:24576
    v_lshrrev_b32 v151, 5, v250
    v_mfma_f32_16x16x32_bf16 v[4:7], v[176:179], v[164:167], v[4:7]
    ds_read_b64_tr_b16 v[194:195], v246 offset:26624
    v_xor_b32 v151, v151, v150
    s_waitcnt vmcnt(0)
    buffer_load_dword v252, v251, s[52:55], s4 offen sc1
    buffer_store_dword v224, v249, s[52:55], s5 offen sc1
    v_mfma_f32_16x16x32_bf16 v[4:7], v[180:183], v[172:175], v[4:7]
    ds_read_b64_tr_b16 v[196:197], v246 offset:28672
    v_xor_b32 v152, 0, v151
    v_mfma_f32_16x16x32_bf16 v[0:3], v[180:183], v[168:171], v[0:3]
    ds_read_b64_tr_b16 v[198:199], v246 offset:30720
    s_waitcnt lgkmcnt(4)
    v_mfma_f32_16x16x32_bf16 v[8:11], v[184:187], v[160:163], v[8:11]
    ds_read_b64_tr_b16 v[200:201], v247 offset:24576
    v_lshl_add_u32 v144, v152, 4, v149
    v_mfma_f32_16x16x32_bf16 v[12:15], v[184:187], v[164:167], v[12:15]
    ds_read_b64_tr_b16 v[202:203], v247 offset:26624
    v_xor_b32 v152, 2, v151
    v_mfma_f32_16x16x32_bf16 v[12:15], v[188:191], v[172:175], v[12:15]
    ds_read_b64_tr_b16 v[204:205], v247 offset:28672
    v_lshl_add_u32 v145, v152, 4, v149
    v_mfma_f32_16x16x32_bf16 v[8:11], v[188:191], v[168:171], v[8:11]
    ds_read_b64_tr_b16 v[206:207], v247 offset:30720
    s_waitcnt lgkmcnt(4)
    v_mfma_f32_16x16x32_bf16 v[16:19], v[192:195], v[160:163], v[16:19]
    v_xor_b32 v152, 4, v151
    v_lshl_add_u32 v146, v152, 4, v149
    v_mfma_f32_16x16x32_bf16 v[20:23], v[192:195], v[164:167], v[20:23]
    v_xor_b32 v152, 6, v151
    v_lshl_add_u32 v147, v152, 4, v149
    v_mfma_f32_16x16x32_bf16 v[20:23], v[196:199], v[172:175], v[20:23]
    v_lshrrev_b32 v151, 3, v250
    s_waitcnt lgkmcnt(0)
    v_mfma_f32_16x16x32_bf16 v[16:19], v[196:199], v[168:171], v[16:19]
    v_xor_b32 v150, v150, v151
    v_lshlrev_b32 v151, 7, v151
    v_mfma_f32_16x16x32_bf16 v[24:27], v[200:203], v[160:163], v[24:27]
    v_lshl_add_u32 v148, v150, 4, v151
    v_add_u32 v148, s70, v148
    v_mfma_f32_16x16x32_bf16 v[28:31], v[200:203], v[164:167], v[28:31]
    s_mov_b32 s79, 0xffff0000
    v_mfma_f32_16x16x32_bf16 v[28:31], v[204:207], v[172:175], v[28:31]
    v_mfma_f32_16x16x32_bf16 v[24:27], v[204:207], v[168:171], v[24:27]
    s_waitcnt vmcnt(1)
    s_branch L_poll
L_ack_far:
    buffer_store_dword v225, v249, s[52:55], s5 offen sc1
    s_branch L_ack_done
L_rescale0:
    v_max3_f32 v240, v64, v65, v66
    v_max3_f32 v240, v240, v67, v72
    v_max3_f32 v240, v240, v73, v74
    v_max3_f32 v240, v240, v75, v80
    v_max3_f32 v240, v240, v81, v82
    v_max3_f32 v240, v240, v83, v88
    v_max3_f32 v240, v240, v89, v90
    v_max_f32 v240, v240, v91
    v_mov_b32 v241, v240
    s_nop 1
    v_permlane16_swap_b32 v240, v241
    v_max_f32 v240, v240, v241
    v_mov_b32 v241, v240
    s_nop 1
    v_permlane32_swap_b32 v240, v241
    v_max_f32 v240, v240, v241
    v_max_f32 v240, 0, v240
    v_ceil_f32 v240, v240
    v_exp_f32 v241, -v240
    v_lshlrev_b32 v242, 16, v136
    v_and_b32 v243, 0xffff0000, v136
    v_mul_f32 v242, v242, v241
    v_mul_f32 v243, v243, v241
    v_cvt_pk_bf16_f32 v136, v242, v243
    v_lshlrev_b32 v242, 16, v137
    v_and_b32 v243, 0xffff0000, v137
    v_mul_f32 v242, v242, v241
    v_mul_f32 v243, v243, v241
    v_cvt_pk_bf16_f32 v137, v242, v243
    v_lshlrev_b32 v242, 16, v138
    v_and_b32 v243, 0xffff0000, v138
    v_mul_f32 v242, v242, v241
    v_mul_f32 v243, v243, v241
    v_cvt_pk_bf16_f32 v138, v242, v243
    v_lshlrev_b32 v242, 16, v139
    v_and_b32 v243, 0xffff0000, v139
    v_mul_f32 v242, v242, v241
    v_mul_f32 v243, v243, v241
    v_cvt_pk_bf16_f32 v139, v242, v243
    v_sub_f32 v64, v64, v240
    v_sub_f32 v65, v65, v240
    v_sub_f32 v66, v66, v240
    v_sub_f32 v67, v67, v240
    v_sub_f32 v72, v72, v240
    v_sub_f32 v73, v73, v240
    v_sub_f32 v74, v74, v240
    v_sub_f32 v75, v75, v240
    v_sub_f32 v80, v80, v240
    v_sub_f32 v81, v81, v240
    v_sub_f32 v82, v82, v240
    v_sub_f32 v83, v83, v240
    v_sub_f32 v88, v88, v240
    v_sub_f32 v89, v89, v240
    v_sub_f32 v90, v90, v240
    v_sub_f32 v91, v91, v240
    v_sub_f32 v216, v216, v240
    v_sub_f32 v217, v217, v240
    v_sub_f32 v218, v218, v240
    v_sub_f32 v219, v219, v240
    v_mul_f32 v0, v0, v241
    v_mul_f32 v1, v1, v241
    v_mul_f32 v2, v2, v241
    v_mul_f32 v3, v3, v241
    v_mul_f32 v8, v8, v241
    v_mul_f32 v9, v9, v241
    v_mul_f32 v10, v10, v241
    v_mul_f32 v11, v11, v241
    v_mul_f32 v16, v16, v241
    v_mul_f32 v17, v17, v241
    v_mul_f32 v18, v18, v241
    v_mul_f32 v19, v19, v241
    v_mul_f32 v24, v24, v241
    v_mul_f32 v25, v25, v241
    v_mul_f32 v26, v26, v241
    v_mul_f32 v27, v27, v241
    v_mul_f32 v32, v32, v241
    v_mul_f32 v33, v33, v241
    v_mul_f32 v34, v34, v241
    v_mul_f32 v35, v35, v241
    v_mul_f32 v40, v40, v241
    v_mul_f32 v41, v41, v241
    v_mul_f32 v42, v42, v241
    v_mul_f32 v43, v43, v241
    v_mul_f32 v48, v48, v241
    v_mul_f32 v49, v49, v241
    v_mul_f32 v50, v50, v241
    v_mul_f32 v51, v51, v241
    v_mul_f32 v56, v56, v241
    v_mul_f32 v57, v57, v241
    v_mul_f32 v58, v58, v241
    v_mul_f32 v59, v59, v241
    v_mul_f32 v208, v208, v241
    v_mul_f32 v209, v209, v241
    v_mul_f32 v210, v210, v241
    v_mul_f32 v211, v211, v241
    v_max3_f32 v240, v68, v69, v70
    v_max3_f32 v240, v240, v71, v76
    v_max3_f32 v240, v240, v77, v78
    v_max3_f32 v240, v240, v79, v84
    v_max3_f32 v240, v240, v85, v86
    v_max3_f32 v240, v240, v87, v92
    v_max3_f32 v240, v240, v93, v94
    v_max_f32 v240, v240, v95
    v_mov_b32 v241, v240
    s_nop 1
    v_permlane16_swap_b32 v240, v241
    v_max_f32 v240, v240, v241
    v_mov_b32 v241, v240
    s_nop 1
    v_permlane32_swap_b32 v240, v241
    v_max_f32 v240, v240, v241
    v_max_f32 v240, 0, v240
    v_ceil_f32 v240, v240
    v_exp_f32 v241, -v240
    v_lshlrev_b32 v242, 16, v140
    v_and_b32 v243, 0xffff0000, v140
    v_mul_f32 v242, v242, v241
    v_mul_f32 v243, v243, v241
    v_cvt_pk_bf16_f32 v140, v242, v243
    v_lshlrev_b32 v242, 16, v141
    v_and_b32 v243, 0xffff0000, v141
    v_mul_f32 v242, v242, v241
    v_mul_f32 v243, v243, v241
    v_cvt_pk_bf16_f32 v141, v242, v243
    v_lshlrev_b32 v242, 16, v142
    v_and_b32 v243, 0xffff0000, v142
    v_mul_f32 v242, v242, v241
    v_mul_f32 v243, v243, v241
    v_cvt_pk_bf16_f32 v142, v242, v243
    v_lshlrev_b32 v242, 16, v143
    v_and_b32 v243, 0xffff0000, v143
    v_mul_f32 v242, v242, v241
    v_mul_f32 v243, v243, v241
    v_cvt_pk_bf16_f32 v143, v242, v243
    v_sub_f32 v68, v68, v240
    v_sub_f32 v69, v69, v240
    v_sub_f32 v70, v70, v240
    v_sub_f32 v71, v71, v240
    v_sub_f32 v76, v76, v240
    v_sub_f32 v77, v77, v240
    v_sub_f32 v78, v78, v240
    v_sub_f32 v79, v79, v240
    v_sub_f32 v84, v84, v240
    v_sub_f32 v85, v85, v240
    v_sub_f32 v86, v86, v240
    v_sub_f32 v87, v87, v240
    v_sub_f32 v92, v92, v240
    v_sub_f32 v93, v93, v240
    v_sub_f32 v94, v94, v240
    v_sub_f32 v95, v95, v240
    v_sub_f32 v220, v220, v240
    v_sub_f32 v221, v221, v240
    v_sub_f32 v222, v222, v240
    v_sub_f32 v223, v223, v240
    v_mul_f32 v4, v4, v241
    v_mul_f32 v5, v5, v241
    v_mul_f32 v6, v6, v241
    v_mul_f32 v7, v7, v241
    v_mul_f32 v12, v12, v241
    v_mul_f32 v13, v13, v241
    v_mul_f32 v14, v14, v241
    v_mul_f32 v15, v15, v241
    v_mul_f32 v20, v20, v241
    v_mul_f32 v21, v21, v241
    v_mul_f32 v22, v22, v241
    v_mul_f32 v23, v23, v241
    v_mul_f32 v28, v28, v241
    v_mul_f32 v29, v29, v241
    v_mul_f32 v30, v30, v241
    v_mul_f32 v31, v31, v241
    v_mul_f32 v36, v36, v241
    v_mul_f32 v37, v37, v241
    v_mul_f32 v38, v38, v241
    v_mul_f32 v39, v39, v241
    v_mul_f32 v44, v44, v241
    v_mul_f32 v45, v45, v241
    v_mul_f32 v46, v46, v241
    v_mul_f32 v47, v47, v241
    v_mul_f32 v52, v52, v241
    v_mul_f32 v53, v53, v241
    v_mul_f32 v54, v54, v241
    v_mul_f32 v55, v55, v241
    v_mul_f32 v60, v60, v241
    v_mul_f32 v61, v61, v241
    v_mul_f32 v62, v62, v241
    v_mul_f32 v63, v63, v241
    v_mul_f32 v212, v212, v241
    v_mul_f32 v213, v213, v241
    v_mul_f32 v214, v214, v241
    v_mul_f32 v215, v215, v241
    s_cmp_eq_u32 s80, 0
    s_cbranch_scc1 L_ret0_0
    s_branch L_ret0_1
L_rescale1:
    v_max3_f32 v240, v96, v97, v98
    v_max3_f32 v240, v240, v99, v104
    v_max3_f32 v240, v240, v105, v106
    v_max3_f32 v240, v240, v107, v112
    v_max3_f32 v240, v240, v113, v114
    v_max3_f32 v240, v240, v115, v120
    v_max3_f32 v240, v240, v121, v122
    v_max_f32 v240, v240, v123
    v_mov_b32 v241, v240
    s_nop 1
    v_permlane16_swap_b32 v240, v241
    v_max_f32 v240, v240, v241
    v_mov_b32 v241, v240
    s_nop 1
    v_permlane32_swap_b32 v240, v241
    v_max_f32 v240, v240, v241
    v_max_f32 v240, 0, v240
    v_ceil_f32 v240, v240
    v_exp_f32 v241, -v240
    v_lshlrev_b32 v242, 16, v136
    v_and_b32 v243, 0xffff0000, v136
    v_mul_f32 v242, v242, v241
    v_mul_f32 v243, v243, v241
    v_cvt_pk_bf16_f32 v136, v242, v243
    v_lshlrev_b32 v242, 16, v137
    v_and_b32 v243, 0xffff0000, v137
    v_mul_f32 v242, v242, v241
    v_mul_f32 v243, v243, v241
    v_cvt_pk_bf16_f32 v137, v242, v243
    v_lshlrev_b32 v242, 16, v138
    v_and_b32 v243, 0xffff0000, v138
    v_mul_f32 v242, v242, v241
    v_mul_f32 v243, v243, v241
    v_cvt_pk_bf16_f32 v138, v242, v243
    v_lshlrev_b32 v242, 16, v139
    v_and_b32 v243, 0xffff0000, v139
    v_mul_f32 v242, v242, v241
    v_mul_f32 v243, v243, v241
    v_cvt_pk_bf16_f32 v139, v242, v243
    v_sub_f32 v96, v96, v240
    v_sub_f32 v97, v97, v240
    v_sub_f32 v98, v98, v240
    v_sub_f32 v99, v99, v240
    v_sub_f32 v104, v104, v240
    v_sub_f32 v105, v105, v240
    v_sub_f32 v106, v106, v240
    v_sub_f32 v107, v107, v240
    v_sub_f32 v112, v112, v240
    v_sub_f32 v113, v113, v240
    v_sub_f32 v114, v114, v240
    v_sub_f32 v115, v115, v240
    v_sub_f32 v120, v120, v240
    v_sub_f32 v121, v121, v240
    v_sub_f32 v122, v122, v240
    v_sub_f32 v123, v123, v240
    v_sub_f32 v216, v216, v240
    v_sub_f32 v217, v217, v240
    v_sub_f32 v218, v218, v240
    v_sub_f32 v219, v219, v240
    v_mul_f32 v0, v0, v241
    v_mul_f32 v1, v1, v241
    v_mul_f32 v2, v2, v241
    v_mul_f32 v3, v3, v241
    v_mul_f32 v8, v8, v241
    v_mul_f32 v9, v9, v241
    v_mul_f32 v10, v10, v241
    v_mul_f32 v11, v11, v241
    v_mul_f32 v16, v16, v241
    v_mul_f32 v17, v17, v241
    v_mul_f32 v18, v18, v241
    v_mul_f32 v19, v19, v241
    v_mul_f32 v24, v24, v241
    v_mul_f32 v25, v25, v241
    v_mul_f32 v26, v26, v241
    v_mul_f32 v27, v27, v241
    v_mul_f32 v32, v32, v241
    v_mul_f32 v33, v33, v241
    v_mul_f32 v34, v34, v241
    v_mul_f32 v35, v35, v241
    v_mul_f32 v40, v40, v241
    v_mul_f32 v41, v41, v241
    v_mul_f32 v42, v42, v241
    v_mul_f32 v43, v43, v241
    v_mul_f32 v48, v48, v241
    v_mul_f32 v49, v49, v241
    v_mul_f32 v50, v50, v241
    v_mul_f32 v51, v51, v241
    v_mul_f32 v56, v56, v241
    v_mul_f32 v57, v57, v241
    v_mul_f32 v58, v58, v241
    v_mul_f32 v59, v59, v241
    v_mul_f32 v208, v208, v241
    v_mul_f32 v209, v209, v241
    v_mul_f32 v210, v210, v241
    v_mul_f32 v211, v211, v241
    v_max3_f32 v240, v100, v101, v102
    v_max3_f32 v240, v240, v103, v108
    v_max3_f32 v240, v240, v109, v110
    v_max3_f32 v240, v240, v111, v116
    v_max3_f32 v240, v240, v117, v118
    v_max3_f32 v240, v240, v119, v124
    v_max3_f32 v240, v240, v125, v126
    v_max_f32 v240, v240, v127
    v_mov_b32 v241, v240
    s_nop 1
    v_permlane16_swap_b32 v240, v241
    v_max_f32 v240, v240, v241
    v_mov_b32 v241, v240
    s_nop 1
    v_permlane32_swap_b32 v240, v241
    v_max_f32 v240, v240, v241
    v_max_f32 v240, 0, v240
    v_ceil_f32 v240, v240
    v_exp_f32 v241, -v240
    v_lshlrev_b32 v242, 16, v140
    v_and_b32 v243, 0xffff0000, v140
    v_mul_f32 v242, v242, v241
    v_mul_f32 v243, v243, v241
    v_cvt_pk_bf16_f32 v140, v242, v243
    v_lshlrev_b32 v242, 16, v141
    v_and_b32 v243, 0xffff0000, v141
    v_mul_f32 v242, v242, v241
    v_mul_f32 v243, v243, v241
    v_cvt_pk_bf16_f32 v141, v242, v243
    v_lshlrev_b32 v242, 16, v142
    v_and_b32 v243, 0xffff0000, v142
    v_mul_f32 v242, v242, v241
    v_mul_f32 v243, v243, v241
    v_cvt_pk_bf16_f32 v142, v242, v243
    v_lshlrev_b32 v242, 16, v143
    v_and_b32 v243, 0xffff0000, v143
    v_mul_f32 v242, v242, v241
    v_mul_f32 v243, v243, v241
    v_cvt_pk_bf16_f32 v143, v242, v243
    v_sub_f32 v100, v100, v240
    v_sub_f32 v101, v101, v240
    v_sub_f32 v102, v102, v240
    v_sub_f32 v103, v103, v240
    v_sub_f32 v108, v108, v240
    v_sub_f32 v109, v109, v240
    v_sub_f32 v110, v110, v240
    v_sub_f32 v111, v111, v240
    v_sub_f32 v116, v116, v240
    v_sub_f32 v117, v117, v240
    v_sub_f32 v118, v118, v240
    v_sub_f32 v119, v119, v240
    v_sub_f32 v124, v124, v240
    v_sub_f32 v125, v125, v240
    v_sub_f32 v126, v126, v240
    v_sub_f32 v127, v127, v240
    v_sub_f32 v220, v220, v240
    v_sub_f32 v221, v221, v240
    v_sub_f32 v222, v222, v240
    v_sub_f32 v223, v223, v240
    v_mul_f32 v4, v4, v241
    v_mul_f32 v5, v5, v241
    v_mul_f32 v6, v6, v241
    v_mul_f32 v7, v7, v241
    v_mul_f32 v12, v12, v241
    v_mul_f32 v13, v13, v241
    v_mul_f32 v14, v14, v241
    v_mul_f32 v15, v15, v241
    v_mul_f32 v20, v20, v241
    v_mul_f32 v21, v21, v241
    v_mul_f32 v22, v22, v241
    v_mul_f32 v23, v23, v241
    v_mul_f32 v28, v28, v241
    v_mul_f32 v29, v29, v241
    v_mul_f32 v30, v30, v241
    v_mul_f32 v31, v31, v241
    v_mul_f32 v36, v36, v241
    v_mul_f32 v37, v37, v241
    v_mul_f32 v38, v38, v241
    v_mul_f32 v39, v39, v241
    v_mul_f32 v44, v44, v241
    v_mul_f32 v45, v45, v241
    v_mul_f32 v46, v46, v241
    v_mul_f32 v47, v47, v241
    v_mul_f32 v52, v52, v241
    v_mul_f32 v53, v53, v241
    v_mul_f32 v54, v54, v241
    v_mul_f32 v55, v55, v241
    v_mul_f32 v60, v60, v241
    v_mul_f32 v61, v61, v241
    v_mul_f32 v62, v62, v241
    v_mul_f32 v63, v63, v241
    v_mul_f32 v212, v212, v241
    v_mul_f32 v213, v213, v241
    v_mul_f32 v214, v214, v241
    v_mul_f32 v215, v215, v241
    s_cmp_eq_u32 s80, 0
    s_cbranch_scc1 L_ret1_0
    s_branch L_ret1_1
L_rescale2:
    v_max3_f32 v240, v96, v97, v98
    v_max3_f32 v240, v240, v99, v104
    v_max3_f32 v240, v240, v105, v106
    v_max3_f32 v240, v240, v107, v112
    v_max3_f32 v240, v240, v113, v114
    v_max3_f32 v240, v240, v115, v120
    v_max3_f32 v240, v240, v121, v122
    v_max_f32 v240, v240, v123
    v_mov_b32 v241, v240
    s_nop 1
    v_permlane16_swap_b32 v240, v241
    v_max_f32 v240, v240, v241
    v_mov_b32 v241, v240
    s_nop 1
    v_permlane32_swap_b32 v240, v241
    v_max_f32 v240, v240, v241
    v_max_f32 v240, 0, v240
    v_ceil_f32 v240, v240
    v_exp_f32 v241, -v240
    v_lshlrev_b32 v242, 16, v136
    v_and_b32 v243, 0xffff0000, v136
    v_mul_f32 v242, v242, v241
    v_mul_f32 v243, v243, v241
    v_cvt_pk_bf16_f32 v136, v242, v243
    v_lshlrev_b32 v242, 16, v137
    v_and_b32 v243, 0xffff0000, v137
    v_mul_f32 v242, v242, v241
    v_mul_f32 v243, v243, v241
    v_cvt_pk_bf16_f32 v137, v242, v243
    v_lshlrev_b32 v242, 16, v138
    v_and_b32 v243, 0xffff0000, v138
    v_mul_f32 v242, v242, v241
    v_mul_f32 v243, v243, v241
    v_cvt_pk_bf16_f32 v138, v242, v243
    v_lshlrev_b32 v242, 16, v139
    v_and_b32 v243, 0xffff0000, v139
    v_mul_f32 v242, v242, v241
    v_mul_f32 v243, v243, v241
    v_cvt_pk_bf16_f32 v139, v242, v243
    v_lshlrev_b32 v242, 16, v128
    v_and_b32 v243, 0xffff0000, v128
    v_mul_f32 v242, v242, v241
    v_mul_f32 v243, v243, v241
    v_cvt_pk_bf16_f32 v128, v242, v243
    v_lshlrev_b32 v242, 16, v129
    v_and_b32 v243, 0xffff0000, v129
    v_mul_f32 v242, v242, v241
    v_mul_f32 v243, v243, v241
    v_cvt_pk_bf16_f32 v129, v242, v243
    v_lshlrev_b32 v242, 16, v130
    v_and_b32 v243, 0xffff0000, v130
    v_mul_f32 v242, v242, v241
    v_mul_f32 v243, v243, v241
    v_cvt_pk_bf16_f32 v130, v242, v243
    v_lshlrev_b32 v242, 16, v131
    v_and_b32 v243, 0xffff0000, v131
    v_mul_f32 v242, v242, v241
    v_mul_f32 v243, v243, v241
    v_cvt_pk_bf16_f32 v131, v242, v243
    v_sub_f32 v96, v96, v240
    v_sub_f32 v97, v97, v240
    v_sub_f32 v98, v98, v240
    v_sub_f32 v99, v99, v240
    v_sub_f32 v104, v104, v240
    v_sub_f32 v105, v105, v240
    v_sub_f32 v106, v106, v240
    v_sub_f32 v107, v107, v240
    v_sub_f32 v112, v112, v240
    v_sub_f32 v113, v113, v240
    v_sub_f32 v114, v114, v240
    v_sub_f32 v115, v115, v240
    v_sub_f32 v120, v120, v240
    v_sub_f32 v121, v121, v240
    v_sub_f32 v122, v122, v240
    v_sub_f32 v123, v123, v240
    v_sub_f32 v216, v216, v240
    v_sub_f32 v217, v217, v240
    v_sub_f32 v218, v218, v240
    v_sub_f32 v219, v219, v240
    v_mul_f32 v0, v0, v241
    v_mul_f32 v1, v1, v241
    v_mul_f32 v2, v2, v241
    v_mul_f32 v3, v3, v241
    v_mul_f32 v8, v8, v241
    v_mul_f32 v9, v9, v241
    v_mul_f32 v10, v10, v241
    v_mul_f32 v11, v11, v241
    v_mul_f32 v16, v16, v241
    v_mul_f32 v17, v17, v241
    v_mul_f32 v18, v18, v241
    v_mul_f32 v19, v19, v241
    v_mul_f32 v24, v24, v241
    v_mul_f32 v25, v25, v241
    v_mul_f32 v26, v26, v241
    v_mul_f32 v27, v27, v241
    v_mul_f32 v32, v32, v241
    v_mul_f32 v33, v33, v241
    v_mul_f32 v34, v34, v241
    v_mul_f32 v35, v35, v241
    v_mul_f32 v40, v40, v241
    v_mul_f32 v41, v41, v241
    v_mul_f32 v42, v42, v241
    v_mul_f32 v43, v43, v241
    v_mul_f32 v48, v48, v241
    v_mul_f32 v49, v49, v241
    v_mul_f32 v50, v50, v241
    v_mul_f32 v51, v51, v241
    v_mul_f32 v56, v56, v241
    v_mul_f32 v57, v57, v241
    v_mul_f32 v58, v58, v241
    v_mul_f32 v59, v59, v241
    v_mul_f32 v208, v208, v241
    v_mul_f32 v209, v209, v241
    v_mul_f32 v210, v210, v241
    v_mul_f32 v211, v211, v241
    v_max3_f32 v240, v100, v101, v102
    v_max3_f32 v240, v240, v103, v108
    v_max3_f32 v240, v240, v109, v110
    v_max3_f32 v240, v240, v111, v116
    v_max3_f32 v240, v240, v117, v118
    v_max3_f32 v240, v240, v119, v124
    v_max3_f32 v240, v240, v125, v126
    v_max_f32 v240, v240, v127
    v_mov_b32 v241, v240
    s_nop 1
    v_permlane16_swap_b32 v240, v241
    v_max_f32 v240, v240, v241
    v_mov_b32 v241, v240
    s_nop 1
    v_permlane32_swap_b32 v240, v241
    v_max_f32 v240, v240, v241
    v_max_f32 v240, 0, v240
    v_ceil_f32 v240, v240
    v_exp_f32 v241, -v240
    v_lshlrev_b32 v242, 16, v140
    v_and_b32 v243, 0xffff0000, v140
    v_mul_f32 v242, v242, v241
    v_mul_f32 v243, v243, v241
    v_cvt_pk_bf16_f32 v140, v242, v243
    v_lshlrev_b32 v242, 16, v141
    v_and_b32 v243, 0xffff0000, v141
    v_mul_f32 v242, v242, v241
    v_mul_f32 v243, v243, v241
    v_cvt_pk_bf16_f32 v141, v242, v243
    v_lshlrev_b32 v242, 16, v142
    v_and_b32 v243, 0xffff0000, v142
    v_mul_f32 v242, v242, v241
    v_mul_f32 v243, v243, v241
    v_cvt_pk_bf16_f32 v142, v242, v243
    v_lshlrev_b32 v242, 16, v143
    v_and_b32 v243, 0xffff0000, v143
    v_mul_f32 v242, v242, v241
    v_mul_f32 v243, v243, v241
    v_cvt_pk_bf16_f32 v143, v242, v243
    v_lshlrev_b32 v242, 16, v132
    v_and_b32 v243, 0xffff0000, v132
    v_mul_f32 v242, v242, v241
    v_mul_f32 v243, v243, v241
    v_cvt_pk_bf16_f32 v132, v242, v243
    v_lshlrev_b32 v242, 16, v133
    v_and_b32 v243, 0xffff0000, v133
    v_mul_f32 v242, v242, v241
    v_mul_f32 v243, v243, v241
    v_cvt_pk_bf16_f32 v133, v242, v243
    v_lshlrev_b32 v242, 16, v134
    v_and_b32 v243, 0xffff0000, v134
    v_mul_f32 v242, v242, v241
    v_mul_f32 v243, v243, v241
    v_cvt_pk_bf16_f32 v134, v242, v243
    v_lshlrev_b32 v242, 16, v135
    v_and_b32 v243, 0xffff0000, v135
    v_mul_f32 v242, v242, v241
    v_mul_f32 v243, v243, v241
    v_cvt_pk_bf16_f32 v135, v242, v243
    v_sub_f32 v100, v100, v240
    v_sub_f32 v101, v101, v240
    v_sub_f32 v102, v102, v240
    v_sub_f32 v103, v103, v240
    v_sub_f32 v108, v108, v240
    v_sub_f32 v109, v109, v240
    v_sub_f32 v110, v110, v240
    v_sub_f32 v111, v111, v240
    v_sub_f32 v116, v116, v240
    v_sub_f32 v117, v117, v240
    v_sub_f32 v118, v118, v240
    v_sub_f32 v119, v119, v240
    v_sub_f32 v124, v124, v240
    v_sub_f32 v125, v125, v240
    v_sub_f32 v126, v126, v240
    v_sub_f32 v127, v127, v240
    v_sub_f32 v220, v220, v240
    v_sub_f32 v221, v221, v240
    v_sub_f32 v222, v222, v240
    v_sub_f32 v223, v223, v240
    v_mul_f32 v4, v4, v241
    v_mul_f32 v5, v5, v241
    v_mul_f32 v6, v6, v241
    v_mul_f32 v7, v7, v241
    v_mul_f32 v12, v12, v241
    v_mul_f32 v13, v13, v241
    v_mul_f32 v14, v14, v241
    v_mul_f32 v15, v15, v241
    v_mul_f32 v20, v20, v241
    v_mul_f32 v21, v21, v241
    v_mul_f32 v22, v22, v241
    v_mul_f32 v23, v23, v241
    v_mul_f32 v28, v28, v241
    v_mul_f32 v29, v29, v241
    v_mul_f32 v30, v30, v241
    v_mul_f32 v31, v31, v241
    v_mul_f32 v36, v36, v241
    v_mul_f32 v37, v37, v241
    v_mul_f32 v38, v38, v241
    v_mul_f32 v39, v39, v241
    v_mul_f32 v44, v44, v241
    v_mul_f32 v45, v45, v241
    v_mul_f32 v46, v46, v241
    v_mul_f32 v47, v47, v241
    v_mul_f32 v52, v52, v241
    v_mul_f32 v53, v53, v241
    v_mul_f32 v54, v54, v241
    v_mul_f32 v55, v55, v241
    v_mul_f32 v60, v60, v241
    v_mul_f32 v61, v61, v241
    v_mul_f32 v62, v62, v241
    v_mul_f32 v63, v63, v241
    v_mul_f32 v212, v212, v241
    v_mul_f32 v213, v213, v241
    v_mul_f32 v214, v214, v241
    v_mul_f32 v215, v215, v241
    s_branch L_ret2_0
L_code_end:
.section .rodata,"a"
.p2align 6
.amdhsa_kernel standalone__tree_speculative_verify_tree_attention_over_candidate_token_tree__sampling_kernel
  .amdhsa_next_free_vgpr 256
  .amdhsa_next_free_sgpr 102
  .amdhsa_accum_offset 256
  .amdhsa_group_segment_fixed_size 0
  .amdhsa_kernarg_size 72
  .amdhsa_user_sgpr_count 2
  .amdhsa_user_sgpr_kernarg_segment_ptr 1
  .amdhsa_system_sgpr_workgroup_id_x 1
.end_amdhsa_kernel
```
